```python
import torch

def _softmax(x, axis=-1):
    return torch.softmax(x, dim=axis)
def _gelu(x):
    return torch.nn.functional.gelu(x, approximate="tanh")
def _silu(x):
    return torch.nn.functional.silu(x)
def _sigmoid(x):
    return torch.sigmoid(x)
def _layernorm(x, axis=-1, eps=1e-5):
    m = x.mean(dim=axis, keepdim=True)
    v = x.var(dim=axis, keepdim=True, unbiased=False)
    return (x - m) / torch.sqrt(v + eps)
def _scatter_add(tgt, idx, src, axis=0):
    return tgt.clone().index_add_(axis, idx, src)
def _segment_sum(src, seg, n):
    out = torch.zeros((n,) + src.shape[1:], dtype=src.dtype)
    return out.index_add_(0, seg, src)
def _pad(x, pw):
    flat = tuple(v for pair in reversed(pw) for v in pair)
    return torch.nn.functional.pad(x, flat)

kernel_name = 'recurrent_scan__softmax_full_mha__geglu_ffn__prompt'

def setup_inputs():

    _w = (lambda a: (lambda t: t.to(torch.bfloat16) if t.is_floating_point() else t)(torch.as_tensor(a)))
    def _A_setup():
        B, S, D = 1, 2048, 640
        return {
            "x": _w((lambda *s: torch.randn(*s, dtype=torch.bfloat16) * 0.05)(B, S, D)),
            "wqkv": _w((lambda *s: torch.randn(*s, dtype=torch.bfloat16) * 0.05)(D, 3 * D)),
            "wo": _w((lambda *s: torch.randn(*s, dtype=torch.bfloat16) * 0.05)(D, D)),
        }
    _A_in = _A_setup()

    def _B_setup():
        B, S, D, F = 1, 2048, 640, 1728
        return {
            "x": _w((lambda *s: torch.randn(*s, dtype=torch.bfloat16) * 0.05)(B, S, D)),
            "w_gate": _w((lambda *s: torch.randn(*s, dtype=torch.bfloat16) * 0.05)(D, F)),
            "w_up": _w((lambda *s: torch.randn(*s, dtype=torch.bfloat16) * 0.05)(D, F)),
            "w_down": _w((lambda *s: torch.randn(*s, dtype=torch.bfloat16) * 0.05)(F, D)),
        }
    _B_in = _B_setup()

    return {
        "A_x": _A_in["x"],
        "A_wqkv": _A_in["wqkv"],
        "A_wo": _A_in["wo"],
        "B_x": _B_in["x"],
        "B_w_gate": _B_in["w_gate"],
        "B_w_up": _B_in["w_up"],
        "B_w_down": _B_in["w_down"],
    }

def reference(A_x, A_wqkv, A_wo, B_x, B_w_gate, B_w_up, B_w_down):
    def _A_ref(x, wqkv, wo):
        B, S, D = x.shape
        H = 32; Dh = D // H
        qkv = (lambda x, *d: x.permute(*d))((x @ wqkv).reshape(B, S, 3, H, Dh), 2, 0, 3, 1, 4)
        q, k, v = qkv[0], qkv[1], qkv[2]
        scale = Dh ** -0.5
        scores = torch.einsum("bhqd,bhkd->bhqk", q, k) * scale
        p = _softmax(scores, axis=-1)
        o = torch.einsum("bhqk,bhkd->bhqd", p, v)
        return (lambda x, *d: x.permute(*d))(o, 0, 2, 1, 3).reshape(B, S, D) @ wo

    def _B_ref(x, w_gate, w_up, w_down):
        return (_gelu(x @ w_gate) * (x @ w_up)) @ w_down

    x = A_x
    xn = _layernorm(x, axis=-1)
    s = _A_ref(xn, A_wqkv, A_wo)
    g = _silu(_B_ref(xn, B_w_gate, B_w_up, B_w_down))
    return x + s * g
```

```asm
; @launch grid=(256,1,1) block=(512,1,1) lds=163840
.amdgcn_target "amdgcn-amd-amdhsa--gfx950"
.text
.globl recurrent_scan__softmax_full_mha__geglu_ffn__prompt_kernel
.p2align 8
.type recurrent_scan__softmax_full_mha__geglu_ffn__prompt_kernel,@function
recurrent_scan__softmax_full_mha__geglu_ffn__prompt_kernel:
  s_cmp_ge_u32 s2, 256
  s_cbranch_scc1 L_end
  s_load_dwordx16 s[4:19], s[0:1], 0
  s_load_dwordx4 s[20:23], s[0:1], 64
  v_lshrrev_b32 v16, 6, v0
  v_and_b32 v1, 63, v0
  v_readfirstlane_b32 s3, v16
  v_lshlrev_b32 v2, 4, v1
  s_cmp_lg_u32 s3, 3
  s_cbranch_scc1 L_nocode
  s_getpc_b64 s[90:91]
L_pc:
  s_bfe_u32 s37, s2, 0x40003
  v_lshl_add_u32 v18, v1, 4, s37
  v_lshlrev_b32 v18, 7, v18
  v_min_u32 v18, L_slow-L_pc-4, v18
  v_mov_b32 v19, s91
  v_add_co_u32 v18, vcc, s90, v18
  s_nop 1
  v_addc_co_u32 v19, vcc, 0, v19, vcc
  s_mov_b64 exec, 0x1ffff
  global_load_dword v221, v[18:19], off
  s_mov_b64 exec, -1
L_nocode:
  s_and_b32 s37, s2, 7
  s_lshl_b32 s37, s37, 2
  s_lshr_b32 s37, 0x76543210, s37
  s_and_b32 s64, s37, 4
  s_bfe_u32 s78, s2, 0x20003
  s_add_u32 s64, s64, s78
  s_lshr_b32 s65, s2, 5
  s_and_b32 s37, s37, 3
  s_lshl2_add_u32 s65, s65, s37
  s_sub_u32 s37, 51, s65
  s_bitcmp1_b32 0x10800000, s65
  s_cselect_b32 s65, s37, s65
  s_sub_u32 s37, 55, s65
  s_bitcmp1_b32 0x42000000, s65
  s_cselect_b32 s65, s37, s65
  s_lshl_b32 s82, s64, 5
  s_add_u32 s82, s82, s65
  s_lshl3_add_u32 s82, s82, s3
  s_mul_i32 s76, s82, 1280
  s_cmp_lt_u32 s65, 27
  s_cselect_b32 s30, 2214912, 0
  s_movk_i32 s38, 3456
  s_cmp_eq_u32 s3, 0
  s_cselect_b32 s30, 2460672, s30
  s_cselect_b32 s38, 3840, s38
  s_cmp_ge_u32 s3, 4
  s_cselect_b32 s30, 2624512, s30
  s_cselect_b32 s38, 1280, s38
  s_cmp_ge_u32 s65, 30
  s_cselect_b32 s30, 0, s30
  s_lshl_b32 s66, s65, 7
  s_lshl_b32 s72, s38, 3
  v_lshrrev_b32 v16, 3, v1
  v_mul_lo_u32 v16, v16, s38
  v_and_b32 v17, 7, v1
  v_lshl_add_u32 v248, v17, 4, v16
  v_lshlrev_b32 v18, 2, v1
  s_mul_i32 s79, s64, s72
  s_lshl_b32 s67, s38, 6
  s_add_u32 s79, s79, s66
  s_mov_b32 s34, 2621440
  s_mov_b32 s35, 0x20000
  s_mov_b32 s31, 0x20000
  s_cmp_eq_u32 s3, 1
  s_waitcnt lgkmcnt(0)
  s_mov_b64 s[32:33], s[4:5]
  s_cselect_b64 s[28:29], s[12:13], s[14:15]
  buffer_load_dwordx4 v[216:219], v2, s[32:35], s76 offen
  buffer_load_dword v220, v18, s[32:35], s76 offen offset:1024
  s_cmp_eq_u32 s3, 0
  s_cselect_b64 s[28:29], s[6:7], s[28:29]
  s_cmp_ge_u32 s3, 4
  s_cselect_b64 s[28:29], s[4:5], s[28:29]
  s_sub_u32 s28, s28, 3072
  s_subb_u32 s29, s29, 0
  s_cmp_ge_u32 s3, 3
  s_cbranch_scc1 L_nocs
  buffer_load_dwordx4 v[200:203], v248, s[28:31], s79 offen offset:3072
  s_add_u32 s79, s79, s67
  buffer_load_dwordx4 v[204:207], v248, s[28:31], s79 offen offset:3072
  s_add_u32 s79, s79, s67
  buffer_load_dwordx4 v[208:211], v248, s[28:31], s79 offen offset:3072
  s_mul_i32 s77, s67, 4
  s_add_u32 s79, s79, s77
L_nocs:
  s_mov_b32 s37, 21516288
  s_load_dword s36, s[22:23], s37
  s_mov_b64 s[24:25], s[22:23]
  s_mov_b32 s26, 21516544
  s_mov_b32 s27, 0x20000
  s_and_b32 s39, s3, 3
  s_lshr_b32 s40, s3, 2
  s_cmp_ge_u32 s65, 30
  s_cbranch_scc1 L_role_r
  s_lshl_b32 s70, s39, 12
  s_add_u32 s77, s70, 65536
  s_movk_i32 s71, 12288
  s_mov_b32 s73, 61440
  s_cmp_eq_u32 s3, 3
  s_cselect_b32 s30, 0, s30
  s_cselect_b32 s70, 61440, s70
  s_cselect_b32 s71, 0, s71
  s_cselect_b32 s73, 0, s73
  s_lshr_b32 s80, s2, 7
  s_lshl1_add_u32 s37, s64, s80
  s_lshl4_add_u32 s37, s37, s39
  s_mul_i32 s37, s37, 10240
  s_mul_i32 s69, s80, 327680
  s_sub_u32 s68, 163840, s69
  s_sub_u32 s69, 128, s68
  s_lshl_b32 s38, s38, 5
  s_bfe_u32 s80, s2, 0x20005
  s_cmp_ge_u32 s3, 4
  s_cselect_b32 s66, s37, s66
  s_cselect_b32 s68, s68, s38
  s_cselect_b32 s69, s69, s38
  s_cselect_b32 s70, s77, s70
  s_cselect_b32 s71, 16384, s71
  s_cselect_b32 s73, 0, s73
  s_cselect_b32 s74, 98304, 0
  s_cselect_b32 s80, s80, s78
  s_cselect_b32 s72, s38, s72
  s_cselect_b64 vcc, -1, 0
  v_lshrrev_b32 v18, 4, v1
  v_and_b32 v19, 1, v18
  v_lshlrev_b32 v19, 2, v19
  s_and_b32 s37, s3, 1
  v_lshl_or_b32 v18, s37, 2, v18
  v_or_b32 v21, 2, v19
  v_cndmask_b32 v20, v21, v18, vcc
  v_cndmask_b32 v18, v19, v18, vcc
  v_xor_b32 v18, v18, v17
  v_xor_b32 v20, v20, v17
  v_lshl_add_u32 v18, v18, 4, v16
  v_lshl_add_u32 v20, v20, 4, v16
  s_xor_b32 s37, s80, 0
  s_mul_i32 s37, s37, s72
  s_add_u32 s37, s37, 3072
  v_add_u32 v244, s37, v18
  s_xor_b32 s37, s80, 1
  s_mul_i32 s37, s37, s72
  s_add_u32 s37, s37, 2048
  v_add_u32 v245, s37, v20
  s_xor_b32 s37, s80, 2
  s_mul_i32 s37, s37, s72
  s_add_u32 s37, s37, 1024
  v_add_u32 v246, s37, v18
  s_xor_b32 s37, s80, 3
  s_mul_i32 s37, s37, s72
  s_add_u32 s37, s37, 0
  v_add_u32 v247, s37, v20
  s_barrier
  s_cmp_eq_u32 s3, 3
  s_cbranch_scc1 L_sk0
  s_mov_b32 m0, s70
  s_add_u32 s70, s70, s71
  buffer_load_dwordx4 v244, s[28:31], s66 offen offset:0 lds
  buffer_load_dwordx4 v245, s[28:31], s66 offen offset:1024 lds
  buffer_load_dwordx4 v246, s[28:31], s66 offen offset:2048 lds
  buffer_load_dwordx4 v247, s[28:31], s66 offen offset:3072 lds
  s_add_u32 s66, s66, s68
L_sk0:
  v_and_b32 v16, 7, v1
  v_lshrrev_b32 v17, 4, v1
  v_bfe_u32 v18, v1, 1, 3
  v_xor_b32 v18, v18, v17
  v_xor_b32 v18, s78, v18
  v_lshlrev_b32 v18, 4, v18
  v_lshl_add_u32 v18, v16, 7, v18
  v_bfe_u32 v16, v1, 3, 1
  v_lshl_add_u32 v18, v16, 12, v18
  s_lshr_b32 s37, s39, 1
  s_mul_i32 s37, s37, 6
  s_add_u32 s37, s37, s39
  s_lshl_b32 s37, s37, 11
  s_add_u32 s37, s37, 65536
  v_add_u32 v236, s37, v18
  v_xor_b32 v237, 64, v236
  v_add_u32 v242, 0x10000, v236
  v_add_u32 v243, 0x10000, v237
  v_bfe_u32 v16, v1, 2, 2
  v_lshl_add_u32 v18, v17, 3, v16
  v_lshlrev_b32 v18, 7, v18
  v_lshrrev_b32 v16, 1, v16
  v_xor_b32 v16, s40, v16
  v_lshl_add_u32 v18, v16, 6, v18
  v_and_b32 v16, 1, v17
  v_lshl_add_u32 v18, v16, 5, v18
  v_and_b32 v16, 3, v1
  v_lshl_add_u32 v240, v16, 3, v18
  v_xor_b32 v241, 32, v240
  v_and_b32 v16, 1, v1
  v_lshlrev_b32 v16, 4, v16
  v_mov_b32 v17, 0x3f80
  v_lshlrev_b32 v16, v16, v17
  v_bfe_u32 v17, v1, 1, 2
  v_cmp_eq_u32 vcc, 0, v17
  s_nop 1
  v_cndmask_b32 v232, 0, v16, vcc
  v_cmp_eq_u32 vcc, 1, v17
  s_nop 1
  v_cndmask_b32 v233, 0, v16, vcc
  v_cmp_eq_u32 vcc, 2, v17
  s_nop 1
  v_cndmask_b32 v234, 0, v16, vcc
  v_cmp_eq_u32 vcc, 3, v17
  s_nop 1
  v_cndmask_b32 v235, 0, v16, vcc
  v_bfe_u32 v16, v1, 3, 1
  v_cmp_eq_u32 s[90:91], 1, v16
  v_and_b32 v17, 7, v1
  v_lshl_add_u32 v17, v17, 3, v16
  v_bfe_u32 v16, v1, 4, 1
  v_lshl_add_u32 v17, v16, 2, v17
  v_lshrrev_b32 v16, 5, v1
  v_lshlrev_b32 v16, 1, v16
  v_add_lshl_u32 v249, v17, v16, 4
  s_mul_i32 s37, s3, 30
  s_add_u32 s37, s37, s65
  s_lshr_b32 s38, s64, 1
  s_lshl2_add_u32 s37, s37, s38
  s_lshl_b32 s37, s37, 7
  s_and_b32 s38, s64, 1
  s_add_u32 s37, s37, s38
  s_lshl_b32 s37, s37, 3
  s_add_u32 s37, s37, 20611072
  s_cmp_lt_u32 s3, 3
  s_cselect_b32 s75, s37, 0x7ff00000
  s_mov_b32 s92, 0
  s_mov_b32 s93, -1
  s_lshr_b32 s76, s2, 6
  s_xor_b32 s76, s76, s39
  s_lshl2_add_u32 s76, s64, s76
  s_bfe_u32 s80, s2, 0x10005
  s_lshl1_add_u32 s80, s76, s80
  s_lshl_b32 s81, s76, 9
  s_add_u32 s81, s81, 20594688
  s_lshl_b32 s83, s65, 3
  s_add_u32 s83, s83, s40
  s_lshl_b32 s83, s83, 9
  s_add_u32 s83, s83, 20611072
  s_add_u32 s84, s83, 122880
  s_add_u32 s85, s83, 245760
  v_and_b32 v238, 15, v1
  v_lshrrev_b32 v239, 4, v1
  v_lshlrev_b32 v239, 6, v239
  v_add_lshl_u32 v239, v239, v238, 4
  s_and_b32 s37, s2, 32
  v_xor_b32 v238, s37, v1
  v_lshlrev_b32 v238, 3, v238
  s_lshl_b32 s37, s65, 12
  s_lshl_b32 s38, s40, 11
  s_add_u32 s37, s37, s38
  s_xor_b32 s38, s80, 1
  s_mul_i32 s86, s80, 122880
  s_mul_i32 s87, s38, 122880
  s_add_u32 s86, s86, s37
  s_add_u32 s87, s87, s37
  s_mul_i32 s62, s80, 110592
  s_mul_i32 s78, s38, 110592
  s_add_u32 s38, s37, 7864320
  s_add_u32 s62, s62, s38
  s_add_u32 s78, s78, s38
  s_lshr_b32 s37, s37, 6
  s_add_u32 s88, s76, s37
  s_lshl_b32 s88, s88, 5
  s_add_u32 s88, s88, 20979712
  s_cmp_lt_u32 s65, 10
  s_cselect_b32 s89, 0x3ea52b5c, 1.0
  s_cmp_eq_u32 s3, 3
  s_cbranch_scc1 L_sk1
  s_mov_b32 m0, s70
  s_add_u32 s70, s70, s71
  buffer_load_dwordx4 v244, s[28:31], s66 offen offset:0 lds
  buffer_load_dwordx4 v245, s[28:31], s66 offen offset:1024 lds
  buffer_load_dwordx4 v246, s[28:31], s66 offen offset:2048 lds
  buffer_load_dwordx4 v247, s[28:31], s66 offen offset:3072 lds
  s_add_u32 s66, s66, s69
L_sk1:
  s_barrier
  s_cmp_eq_u32 s3, 3
  s_cbranch_scc1 L_sk2
  s_mov_b32 m0, s70
  s_add_u32 s70, s70, s71
  buffer_load_dwordx4 v244, s[28:31], s66 offen offset:0 lds
  buffer_load_dwordx4 v245, s[28:31], s66 offen offset:1024 lds
  buffer_load_dwordx4 v246, s[28:31], s66 offen offset:2048 lds
  buffer_load_dwordx4 v247, s[28:31], s66 offen offset:3072 lds
  s_add_u32 s66, s66, s68
L_sk2:
  s_waitcnt vmcnt(12)
  s_cmp_lg_u32 s3, 3
  s_cbranch_scc1 L_skw
  s_waitcnt vmcnt(0)
L_skw:
  v_lshlrev_b32 v222, 16, v216
  v_and_b32 v223, 0xffff0000, v216
  v_lshlrev_b32 v224, 16, v217
  v_and_b32 v225, 0xffff0000, v217
  v_lshlrev_b32 v226, 16, v218
  v_and_b32 v227, 0xffff0000, v218
  v_lshlrev_b32 v228, 16, v219
  v_and_b32 v229, 0xffff0000, v219
  v_lshlrev_b32 v230, 16, v220
  v_and_b32 v231, 0xffff0000, v220
  v_add_f32 v16, v222, v223
  v_add_f32 v16, v16, v224
  v_add_f32 v16, v16, v225
  v_add_f32 v16, v16, v226
  v_add_f32 v16, v16, v227
  v_add_f32 v16, v16, v228
  v_add_f32 v16, v16, v229
  v_add_f32 v16, v16, v230
  v_add_f32 v16, v16, v231
  s_nop 1
  v_add_f32_dpp v16, v16, v16 quad_perm:[1,0,3,2] row_mask:0xf bank_mask:0xf
  s_nop 1
  v_add_f32_dpp v16, v16, v16 quad_perm:[2,3,0,1] row_mask:0xf bank_mask:0xf
  s_nop 1
  v_add_f32_dpp v16, v16, v16 row_half_mirror row_mask:0xf bank_mask:0xf
  s_nop 1
  v_add_f32_dpp v16, v16, v16 row_mirror row_mask:0xf bank_mask:0xf
  s_nop 1
  v_add_f32_dpp v16, v16, v16 row_bcast:15 row_mask:0xa bank_mask:0xf
  s_nop 1
  v_add_f32_dpp v16, v16, v16 row_bcast:31 row_mask:0xc bank_mask:0xf
  v_mul_f32 v16, 0x3acccccd, v16
  s_nop 0
  v_readlane_b32 s37, v16, 63
  s_nop 1
  v_subrev_f32 v222, s37, v222
  v_subrev_f32 v223, s37, v223
  v_subrev_f32 v224, s37, v224
  v_subrev_f32 v225, s37, v225
  v_subrev_f32 v226, s37, v226
  v_subrev_f32 v227, s37, v227
  v_subrev_f32 v228, s37, v228
  v_subrev_f32 v229, s37, v229
  v_subrev_f32 v230, s37, v230
  v_subrev_f32 v231, s37, v231
  v_mul_f32 v17, v222, v222
  v_fmac_f32 v17, v223, v223
  v_fmac_f32 v17, v224, v224
  v_fmac_f32 v17, v225, v225
  v_fmac_f32 v17, v226, v226
  v_fmac_f32 v17, v227, v227
  v_fmac_f32 v17, v228, v228
  v_fmac_f32 v17, v229, v229
  v_fmac_f32 v17, v230, v230
  v_fmac_f32 v17, v231, v231
  s_waitcnt lgkmcnt(0)
  s_mul_i32 s36, s36, 0x9e3779b1
  s_add_u32 s36, s36, 0x7f4a7c15
  v_mov_b32 v3, s36
  v_add_f32_dpp v17, v17, v17 quad_perm:[1,0,3,2] row_mask:0xf bank_mask:0xf
  s_nop 1
  v_add_f32_dpp v17, v17, v17 quad_perm:[2,3,0,1] row_mask:0xf bank_mask:0xf
  s_nop 1
  v_add_f32_dpp v17, v17, v17 row_half_mirror row_mask:0xf bank_mask:0xf
  s_nop 1
  v_add_f32_dpp v17, v17, v17 row_mirror row_mask:0xf bank_mask:0xf
  s_nop 1
  v_add_f32_dpp v17, v17, v17 row_bcast:15 row_mask:0xa bank_mask:0xf
  s_nop 1
  v_add_f32_dpp v17, v17, v17 row_bcast:31 row_mask:0xc bank_mask:0xf
  v_mul_f32 v17, 0x3acccccd, v17
  v_cvt_pk_bf16_f32 v17, v17, v17
  v_and_b32 v17, 0xffff0000, v17
  v_add_f32 v17, 0x3727c5ac, v17
  v_cvt_pk_bf16_f32 v17, v17, v17
  v_and_b32 v17, 0xffff0000, v17
  v_sqrt_f32 v17, v17
  v_mov_b32 v19, v3
  v_cvt_pk_bf16_f32 v18, -v16, v17
  s_lshl_b32 s37, s82, 3
  s_add_u32 s37, s37, 20594688
  s_cmp_eq_u32 s3, 3
  s_cbranch_scc1 L_sk3
  s_mov_b32 m0, s70
  s_add_u32 s70, s70, s71
  buffer_load_dwordx4 v244, s[28:31], s66 offen offset:0 lds
  buffer_load_dwordx4 v245, s[28:31], s66 offen offset:1024 lds
  buffer_load_dwordx4 v246, s[28:31], s66 offen offset:2048 lds
  buffer_load_dwordx4 v247, s[28:31], s66 offen offset:3072 lds
  s_add_u32 s66, s66, s69
L_sk3:
  s_mov_b32 exec_lo, 0
  s_brev_b32 exec_hi, 1
  buffer_store_dwordx2 v[18:19], off, s[24:27], s37 sc1
  s_mov_b64 exec, -1
  s_waitcnt vmcnt(9)
  s_barrier
  ds_read_b128 v[168:171], v236 offset:0
  ds_read_b64_tr_b16 v[120:121], v240 offset:0
  ds_read_b64_tr_b16 v[122:123], v240 offset:512
  ds_read_b128 v[172:175], v236 offset:8192
  ds_read_b128 v[176:179], v236 offset:1024
  ds_read_b128 v[180:183], v236 offset:9216
  ds_read_b64_tr_b16 v[124:125], v241 offset:0
  ds_read_b64_tr_b16 v[126:127], v241 offset:512
  ds_read_b64_tr_b16 v[128:129], v240 offset:4096
  ds_read_b64_tr_b16 v[130:131], v240 offset:4608
  ds_read_b64_tr_b16 v[132:133], v241 offset:4096
  ds_read_b64_tr_b16 v[134:135], v241 offset:4608
  ds_read_b64_tr_b16 v[136:137], v240 offset:8192
  ds_read_b64_tr_b16 v[138:139], v240 offset:8704
  ds_read_b64_tr_b16 v[140:141], v241 offset:8192
  ds_read_b64_tr_b16 v[142:143], v241 offset:8704
  s_cmp_eq_u32 s3, 3
  s_cselect_b64 vcc, -1, 0
  s_cmp_ge_u32 s3, 3
  s_cbranch_scc1 L_cs1
  v_mfma_f32_16x16x32_bf16 v[224:227], v[232:235], v[200:203], 0
  v_mfma_f32_16x16x32_bf16 v[224:227], v[232:235], v[204:207], v[224:227]
  v_mfma_f32_16x16x32_bf16 v[224:227], v[232:235], v[208:211], v[224:227]
L_cs1:
  s_waitcnt lgkmcnt(13)
  v_mfma_f32_16x16x32_bf16 v[24:27], v[120:123], v[168:171], 0
  s_waitcnt lgkmcnt(12)
  v_mfma_f32_16x16x32_bf16 v[32:35], v[120:123], v[172:175], 0
  s_setprio 2
  s_waitcnt lgkmcnt(11)
  v_mfma_f32_16x16x32_bf16 v[40:43], v[120:123], v[176:179], 0
  s_mov_b32 m0, s70
  s_add_u32 s70, s70, s71
  s_cbranch_vccnz L_skl0_2
  buffer_load_dwordx4 v244, s[28:31], s66 offen offset:0 lds
L_skl0_2:
  s_waitcnt lgkmcnt(10)
  v_mfma_f32_16x16x32_bf16 v[48:51], v[120:123], v[180:183], 0
  s_waitcnt lgkmcnt(8)
  v_mfma_f32_16x16x32_bf16 v[28:31], v[124:127], v[168:171], 0
  v_mfma_f32_16x16x32_bf16 v[36:39], v[124:127], v[172:175], 0
  v_mfma_f32_16x16x32_bf16 v[44:47], v[124:127], v[176:179], 0
  ds_read_b128 v[184:187], v237 offset:0
  s_cbranch_vccnz L_skl0_6
  buffer_load_dwordx4 v245, s[28:31], s66 offen offset:1024 lds
L_skl0_6:
  v_mfma_f32_16x16x32_bf16 v[52:55], v[124:127], v[180:183], 0
  ds_read_b64_tr_b16 v[144:145], v240 offset:12288
  s_waitcnt lgkmcnt(2)
  v_mfma_f32_16x16x32_bf16 v[56:59], v[128:131], v[168:171], 0
  ds_read_b64_tr_b16 v[146:147], v240 offset:12800
  v_mfma_f32_16x16x32_bf16 v[64:67], v[128:131], v[172:175], 0
  s_barrier
  ds_read_b128 v[188:191], v237 offset:8192
  v_mfma_f32_16x16x32_bf16 v[72:75], v[128:131], v[176:179], 0
  ds_read_b128 v[192:195], v237 offset:1024
  s_cbranch_vccnz L_skl0_10
  buffer_load_dwordx4 v246, s[28:31], s66 offen offset:2048 lds
L_skl0_10:
  v_mfma_f32_16x16x32_bf16 v[80:83], v[128:131], v[180:183], 0
  ds_read_b128 v[196:199], v237 offset:9216
  v_mfma_f32_16x16x32_bf16 v[60:63], v[132:135], v[168:171], 0
  ds_read_b64_tr_b16 v[148:149], v241 offset:12288
  v_mfma_f32_16x16x32_bf16 v[68:71], v[132:135], v[172:175], 0
  ds_read_b64_tr_b16 v[150:151], v241 offset:12800
  v_mfma_f32_16x16x32_bf16 v[76:79], v[132:135], v[176:179], 0
  ds_read_b64_tr_b16 v[152:153], v240 offset:16384
  s_cbranch_vccnz L_skl0_14
  buffer_load_dwordx4 v247, s[28:31], s66 offen offset:3072 lds
L_skl0_14:
  s_add_u32 s66, s66, s68
  s_sub_u32 s70, s70, s73
  v_mfma_f32_16x16x32_bf16 v[84:87], v[132:135], v[180:183], 0
  ds_read_b64_tr_b16 v[154:155], v240 offset:16896
  v_mfma_f32_16x16x32_bf16 v[88:91], v[136:139], v[168:171], 0
  s_setprio 1
  ds_read_b64_tr_b16 v[156:157], v241 offset:16384
  v_mfma_f32_16x16x32_bf16 v[96:99], v[136:139], v[172:175], 0
  ds_read_b64_tr_b16 v[158:159], v241 offset:16896
  v_mfma_f32_16x16x32_bf16 v[104:107], v[136:139], v[176:179], 0
  ds_read_b64_tr_b16 v[160:161], v240 offset:20480
  s_mov_b32 m0, s70
  s_add_u32 s70, s70, s71
  s_cbranch_vccnz L_skl0_18
  buffer_load_dwordx4 v244, s[28:31], s66 offen offset:0 lds
L_skl0_18:
  v_mfma_f32_16x16x32_bf16 v[112:115], v[136:139], v[180:183], 0
  ds_read_b64_tr_b16 v[162:163], v240 offset:20992
  v_mfma_f32_16x16x32_bf16 v[92:95], v[140:143], v[168:171], 0
  ds_read_b64_tr_b16 v[164:165], v241 offset:20480
  v_mfma_f32_16x16x32_bf16 v[100:103], v[140:143], v[172:175], 0
  s_setprio 0
  ds_read_b64_tr_b16 v[166:167], v241 offset:20992
  v_mfma_f32_16x16x32_bf16 v[108:111], v[140:143], v[176:179], 0
  s_cbranch_vccnz L_skl0_22
  buffer_load_dwordx4 v245, s[28:31], s66 offen offset:1024 lds
L_skl0_22:
  v_mfma_f32_16x16x32_bf16 v[116:119], v[140:143], v[180:183], 0
  s_waitcnt lgkmcnt(0)
  v_mfma_f32_16x16x32_bf16 v[24:27], v[144:147], v[184:187], v[24:27]
  v_mfma_f32_16x16x32_bf16 v[32:35], v[144:147], v[188:191], v[32:35]
  s_waitcnt vmcnt(7)
  s_barrier
  s_setprio 2
  v_mfma_f32_16x16x32_bf16 v[40:43], v[144:147], v[192:195], v[40:43]
  ds_read_b128 v[168:171], v236 offset:32768
  s_cbranch_vccnz L_skl1_2
  buffer_load_dwordx4 v246, s[28:31], s66 offen offset:2048 lds
L_skl1_2:
  v_mfma_f32_16x16x32_bf16 v[48:51], v[144:147], v[196:199], v[48:51]
  ds_read_b64_tr_b16 v[120:121], v240 offset:24576
  v_mfma_f32_16x16x32_bf16 v[28:31], v[148:151], v[184:187], v[28:31]
  ds_read_b64_tr_b16 v[122:123], v240 offset:25088
  v_mfma_f32_16x16x32_bf16 v[36:39], v[148:151], v[188:191], v[36:39]
  ds_read_b128 v[172:175], v236 offset:40960
  v_mfma_f32_16x16x32_bf16 v[44:47], v[148:151], v[192:195], v[44:47]
  ds_read_b128 v[176:179], v236 offset:33792
  s_cbranch_vccnz L_skl1_6
  buffer_load_dwordx4 v247, s[28:31], s66 offen offset:3072 lds
L_skl1_6:
  s_add_u32 s66, s66, s69
  s_sub_u32 s70, s70, s74
  v_mfma_f32_16x16x32_bf16 v[52:55], v[148:151], v[196:199], v[52:55]
  ds_read_b128 v[180:183], v236 offset:41984
  v_mfma_f32_16x16x32_bf16 v[56:59], v[152:155], v[184:187], v[56:59]
  ds_read_b64_tr_b16 v[124:125], v241 offset:24576
  v_mfma_f32_16x16x32_bf16 v[64:67], v[152:155], v[188:191], v[64:67]
  ds_read_b64_tr_b16 v[126:127], v241 offset:25088
  v_mfma_f32_16x16x32_bf16 v[72:75], v[152:155], v[192:195], v[72:75]
  ds_read_b64_tr_b16 v[128:129], v240 offset:28672
  s_mov_b32 m0, s70
  s_add_u32 s70, s70, s71
  s_cbranch_vccnz L_skl1_10
  buffer_load_dwordx4 v244, s[28:31], s66 offen offset:0 lds
L_skl1_10:
  v_mfma_f32_16x16x32_bf16 v[80:83], v[152:155], v[196:199], v[80:83]
  ds_read_b64_tr_b16 v[130:131], v240 offset:29184
  v_mfma_f32_16x16x32_bf16 v[60:63], v[156:159], v[184:187], v[60:63]
  ds_read_b64_tr_b16 v[132:133], v241 offset:28672
  v_mfma_f32_16x16x32_bf16 v[68:71], v[156:159], v[188:191], v[68:71]
  ds_read_b64_tr_b16 v[134:135], v241 offset:29184
  v_mfma_f32_16x16x32_bf16 v[76:79], v[156:159], v[192:195], v[76:79]
  ds_read_b64_tr_b16 v[136:137], v240 offset:32768
  s_cbranch_vccnz L_skl1_14
  buffer_load_dwordx4 v245, s[28:31], s66 offen offset:1024 lds
L_skl1_14:
  v_mfma_f32_16x16x32_bf16 v[84:87], v[156:159], v[196:199], v[84:87]
  ds_read_b64_tr_b16 v[138:139], v240 offset:33280
  v_mfma_f32_16x16x32_bf16 v[88:91], v[160:163], v[184:187], v[88:91]
  s_setprio 1
  ds_read_b64_tr_b16 v[140:141], v241 offset:32768
  v_mfma_f32_16x16x32_bf16 v[96:99], v[160:163], v[188:191], v[96:99]
  ds_read_b64_tr_b16 v[142:143], v241 offset:33280
  v_mfma_f32_16x16x32_bf16 v[104:107], v[160:163], v[192:195], v[104:107]
  s_cbranch_vccnz L_skl1_18
  buffer_load_dwordx4 v246, s[28:31], s66 offen offset:2048 lds
L_skl1_18:
  v_mfma_f32_16x16x32_bf16 v[112:115], v[160:163], v[196:199], v[112:115]
  v_mfma_f32_16x16x32_bf16 v[92:95], v[164:167], v[184:187], v[92:95]
  v_mfma_f32_16x16x32_bf16 v[100:103], v[164:167], v[188:191], v[100:103]
  s_setprio 0
  v_mfma_f32_16x16x32_bf16 v[108:111], v[164:167], v[192:195], v[108:111]
  s_cbranch_vccnz L_skl1_22
  buffer_load_dwordx4 v247, s[28:31], s66 offen offset:3072 lds
L_skl1_22:
  s_add_u32 s66, s66, s68
  v_mfma_f32_16x16x32_bf16 v[116:119], v[164:167], v[196:199], v[116:119]
  s_waitcnt lgkmcnt(0)
  v_mfma_f32_16x16x32_bf16 v[24:27], v[120:123], v[168:171], v[24:27]
  v_mfma_f32_16x16x32_bf16 v[32:35], v[120:123], v[172:175], v[32:35]
  s_barrier
  s_setprio 2
  v_mfma_f32_16x16x32_bf16 v[40:43], v[120:123], v[176:179], v[40:43]
  ds_read_b128 v[184:187], v237 offset:32768
  v_mfma_f32_16x16x32_bf16 v[48:51], v[120:123], v[180:183], v[48:51]
  ds_read_b64_tr_b16 v[144:145], v240 offset:36864
  v_mfma_f32_16x16x32_bf16 v[28:31], v[124:127], v[168:171], v[28:31]
  s_mov_b32 m0, s70
  s_add_u32 s70, s70, s71
  s_cbranch_vccnz L_skl2_4
  buffer_load_dwordx4 v244, s[28:31], s66 offen offset:0 lds
L_skl2_4:
  v_mfma_f32_16x16x32_bf16 v[36:39], v[124:127], v[172:175], v[36:39]
  ds_read_b64_tr_b16 v[146:147], v240 offset:37376
  v_mfma_f32_16x16x32_bf16 v[44:47], v[124:127], v[176:179], v[44:47]
  ds_read_b128 v[188:191], v237 offset:40960
  v_mfma_f32_16x16x32_bf16 v[52:55], v[124:127], v[180:183], v[52:55]
  ds_read_b128 v[192:195], v237 offset:33792
  v_mfma_f32_16x16x32_bf16 v[56:59], v[128:131], v[168:171], v[56:59]
  ds_read_b128 v[196:199], v237 offset:41984
  v_mfma_f32_16x16x32_bf16 v[64:67], v[128:131], v[172:175], v[64:67]
  ds_read_b64_tr_b16 v[148:149], v241 offset:36864
  v_mfma_f32_16x16x32_bf16 v[72:75], v[128:131], v[176:179], v[72:75]
  s_cbranch_vccnz L_skl2_10
  buffer_load_dwordx4 v245, s[28:31], s66 offen offset:1024 lds
L_skl2_10:
  v_mfma_f32_16x16x32_bf16 v[80:83], v[128:131], v[180:183], v[80:83]
  ds_read_b64_tr_b16 v[150:151], v241 offset:37376
  v_mfma_f32_16x16x32_bf16 v[60:63], v[132:135], v[168:171], v[60:63]
  ds_read_b64_tr_b16 v[152:153], v240 offset:40960
  v_mfma_f32_16x16x32_bf16 v[68:71], v[132:135], v[172:175], v[68:71]
  ds_read_b64_tr_b16 v[154:155], v240 offset:41472
  v_mfma_f32_16x16x32_bf16 v[76:79], v[132:135], v[176:179], v[76:79]
  ds_read_b64_tr_b16 v[156:157], v241 offset:40960
  v_mfma_f32_16x16x32_bf16 v[84:87], v[132:135], v[180:183], v[84:87]
  ds_read_b64_tr_b16 v[158:159], v241 offset:41472
  v_mfma_f32_16x16x32_bf16 v[88:91], v[136:139], v[168:171], v[88:91]
  s_setprio 1
  s_cbranch_vccnz L_skl2_16
  buffer_load_dwordx4 v246, s[28:31], s66 offen offset:2048 lds
L_skl2_16:
  v_mfma_f32_16x16x32_bf16 v[96:99], v[136:139], v[172:175], v[96:99]
  ds_read_b64_tr_b16 v[160:161], v240 offset:45056
  v_mfma_f32_16x16x32_bf16 v[104:107], v[136:139], v[176:179], v[104:107]
  ds_read_b64_tr_b16 v[162:163], v240 offset:45568
  v_mfma_f32_16x16x32_bf16 v[112:115], v[136:139], v[180:183], v[112:115]
  ds_read_b64_tr_b16 v[164:165], v241 offset:45056
  v_mfma_f32_16x16x32_bf16 v[92:95], v[140:143], v[168:171], v[92:95]
  ds_read_b64_tr_b16 v[166:167], v241 offset:45568
  v_mfma_f32_16x16x32_bf16 v[100:103], v[140:143], v[172:175], v[100:103]
  s_setprio 0
  s_cbranch_vccnz L_skl2_21
  buffer_load_dwordx4 v247, s[28:31], s66 offen offset:3072 lds
L_skl2_21:
  s_add_u32 s66, s66, s69
  v_mfma_f32_16x16x32_bf16 v[108:111], v[140:143], v[176:179], v[108:111]
  v_mfma_f32_16x16x32_bf16 v[116:119], v[140:143], v[180:183], v[116:119]
  s_waitcnt lgkmcnt(0)
  v_mfma_f32_16x16x32_bf16 v[24:27], v[144:147], v[184:187], v[24:27]
  v_mfma_f32_16x16x32_bf16 v[32:35], v[144:147], v[188:191], v[32:35]
  s_waitcnt vmcnt(8)
  s_barrier
  s_setprio 2
  v_mfma_f32_16x16x32_bf16 v[40:43], v[144:147], v[192:195], v[40:43]
  ds_read_b128 v[168:171], v242 offset:0
  v_mfma_f32_16x16x32_bf16 v[48:51], v[144:147], v[196:199], v[48:51]
  ds_read_b64_tr_b16 v[120:121], v240 offset:49152
  v_mfma_f32_16x16x32_bf16 v[28:31], v[148:151], v[184:187], v[28:31]
  s_mov_b32 m0, s70
  s_add_u32 s70, s70, s71
  s_cbranch_vccnz L_skl3_4
  buffer_load_dwordx4 v244, s[28:31], s66 offen offset:0 lds
L_skl3_4:
  v_mfma_f32_16x16x32_bf16 v[36:39], v[148:151], v[188:191], v[36:39]
  ds_read_b64_tr_b16 v[122:123], v240 offset:49664
  v_mfma_f32_16x16x32_bf16 v[44:47], v[148:151], v[192:195], v[44:47]
  ds_read_b128 v[172:175], v242 offset:8192
  v_mfma_f32_16x16x32_bf16 v[52:55], v[148:151], v[196:199], v[52:55]
  ds_read_b128 v[176:179], v242 offset:1024
  v_mfma_f32_16x16x32_bf16 v[56:59], v[152:155], v[184:187], v[56:59]
  ds_read_b128 v[180:183], v242 offset:9216
  v_mfma_f32_16x16x32_bf16 v[64:67], v[152:155], v[188:191], v[64:67]
  ds_read_b64_tr_b16 v[124:125], v241 offset:49152
  v_mfma_f32_16x16x32_bf16 v[72:75], v[152:155], v[192:195], v[72:75]
  s_cbranch_vccnz L_skl3_10
  buffer_load_dwordx4 v245, s[28:31], s66 offen offset:1024 lds
L_skl3_10:
  v_mfma_f32_16x16x32_bf16 v[80:83], v[152:155], v[196:199], v[80:83]
  ds_read_b64_tr_b16 v[126:127], v241 offset:49664
  v_mfma_f32_16x16x32_bf16 v[60:63], v[156:159], v[184:187], v[60:63]
  ds_read_b64_tr_b16 v[128:129], v240 offset:53248
  v_mfma_f32_16x16x32_bf16 v[68:71], v[156:159], v[188:191], v[68:71]
  ds_read_b64_tr_b16 v[130:131], v240 offset:53760
  v_mfma_f32_16x16x32_bf16 v[76:79], v[156:159], v[192:195], v[76:79]
  ds_read_b64_tr_b16 v[132:133], v241 offset:53248
  v_mfma_f32_16x16x32_bf16 v[84:87], v[156:159], v[196:199], v[84:87]
  ds_read_b64_tr_b16 v[134:135], v241 offset:53760
  v_mfma_f32_16x16x32_bf16 v[88:91], v[160:163], v[184:187], v[88:91]
  s_setprio 1
  s_cbranch_vccnz L_skl3_16
  buffer_load_dwordx4 v246, s[28:31], s66 offen offset:2048 lds
L_skl3_16:
  v_mfma_f32_16x16x32_bf16 v[96:99], v[160:163], v[188:191], v[96:99]
  ds_read_b64_tr_b16 v[136:137], v240 offset:57344
  v_mfma_f32_16x16x32_bf16 v[104:107], v[160:163], v[192:195], v[104:107]
  ds_read_b64_tr_b16 v[138:139], v240 offset:57856
  v_mfma_f32_16x16x32_bf16 v[112:115], v[160:163], v[196:199], v[112:115]
  ds_read_b64_tr_b16 v[140:141], v241 offset:57344
  v_mfma_f32_16x16x32_bf16 v[92:95], v[164:167], v[184:187], v[92:95]
  ds_read_b64_tr_b16 v[142:143], v241 offset:57856
  v_mfma_f32_16x16x32_bf16 v[100:103], v[164:167], v[188:191], v[100:103]
  s_setprio 0
  s_cbranch_vccnz L_skl3_21
  buffer_load_dwordx4 v247, s[28:31], s66 offen offset:3072 lds
L_skl3_21:
  s_add_u32 s66, s66, s68
  v_mfma_f32_16x16x32_bf16 v[108:111], v[164:167], v[192:195], v[108:111]
  v_mfma_f32_16x16x32_bf16 v[116:119], v[164:167], v[196:199], v[116:119]
  s_waitcnt lgkmcnt(0)
  v_mfma_f32_16x16x32_bf16 v[24:27], v[120:123], v[168:171], v[24:27]
  v_mfma_f32_16x16x32_bf16 v[32:35], v[120:123], v[172:175], v[32:35]
  s_barrier
  s_setprio 2
  v_mfma_f32_16x16x32_bf16 v[40:43], v[120:123], v[176:179], v[40:43]
  ds_read_b128 v[184:187], v243 offset:0
  v_mfma_f32_16x16x32_bf16 v[48:51], v[120:123], v[180:183], v[48:51]
  ds_read_b64_tr_b16 v[144:145], v240 offset:0
  v_mfma_f32_16x16x32_bf16 v[28:31], v[124:127], v[168:171], v[28:31]
  s_mov_b32 m0, s70
  s_add_u32 s70, s70, s71
  s_cbranch_vccnz L_skl4_4
  buffer_load_dwordx4 v244, s[28:31], s66 offen offset:0 lds
L_skl4_4:
  v_mfma_f32_16x16x32_bf16 v[36:39], v[124:127], v[172:175], v[36:39]
  ds_read_b64_tr_b16 v[146:147], v240 offset:512
  v_mfma_f32_16x16x32_bf16 v[44:47], v[124:127], v[176:179], v[44:47]
  ds_read_b128 v[188:191], v243 offset:8192
  v_mfma_f32_16x16x32_bf16 v[52:55], v[124:127], v[180:183], v[52:55]
  ds_read_b128 v[192:195], v243 offset:1024
  s_cmp_lg_u32 s39, 3
  s_cbranch_scc1 L_fqp
  s_mov_b64 exec, 1
  buffer_load_dword v218, off, s[24:27], s88 sc1
  s_mov_b64 exec, -1
L_fqp:
  s_cmp_ge_u32 s3, 3
  s_cbranch_scc1 L_c1
  buffer_load_dwordx4 v[200:203], v248, s[28:31], s79 offen offset:3072
  s_add_u32 s79, s79, s67
  buffer_load_dwordx4 v[204:207], v248, s[28:31], s79 offen offset:3072
  s_add_u32 s79, s79, s67
  buffer_load_dwordx4 v[208:211], v248, s[28:31], s79 offen offset:3072
  s_add_u32 s79, s79, s67
  buffer_load_dwordx4 v[212:215], v248, s[28:31], s79 offen offset:3072
  s_mul_i32 s77, s67, -6
  s_add_u32 s79, s79, s77
L_c1:
  v_mfma_f32_16x16x32_bf16 v[56:59], v[128:131], v[168:171], v[56:59]
  ds_read_b128 v[196:199], v243 offset:9216
  v_mfma_f32_16x16x32_bf16 v[64:67], v[128:131], v[172:175], v[64:67]
  ds_read_b64_tr_b16 v[148:149], v241 offset:0
  v_mfma_f32_16x16x32_bf16 v[72:75], v[128:131], v[176:179], v[72:75]
  s_cbranch_vccnz L_skl4_10
  buffer_load_dwordx4 v245, s[28:31], s66 offen offset:1024 lds
L_skl4_10:
  v_mfma_f32_16x16x32_bf16 v[80:83], v[128:131], v[180:183], v[80:83]
  ds_read_b64_tr_b16 v[150:151], v241 offset:512
  v_mfma_f32_16x16x32_bf16 v[60:63], v[132:135], v[168:171], v[60:63]
  ds_read_b64_tr_b16 v[152:153], v240 offset:4096
  v_mfma_f32_16x16x32_bf16 v[68:71], v[132:135], v[172:175], v[68:71]
  ds_read_b64_tr_b16 v[154:155], v240 offset:4608
  v_mfma_f32_16x16x32_bf16 v[76:79], v[132:135], v[176:179], v[76:79]
  ds_read_b64_tr_b16 v[156:157], v241 offset:4096
  v_mfma_f32_16x16x32_bf16 v[84:87], v[132:135], v[180:183], v[84:87]
  ds_read_b64_tr_b16 v[158:159], v241 offset:4608
  v_mfma_f32_16x16x32_bf16 v[88:91], v[136:139], v[168:171], v[88:91]
  s_setprio 1
  s_cbranch_vccnz L_skl4_16
  buffer_load_dwordx4 v246, s[28:31], s66 offen offset:2048 lds
L_skl4_16:
  v_mfma_f32_16x16x32_bf16 v[96:99], v[136:139], v[172:175], v[96:99]
  ds_read_b64_tr_b16 v[160:161], v240 offset:8192
  v_mfma_f32_16x16x32_bf16 v[104:107], v[136:139], v[176:179], v[104:107]
  ds_read_b64_tr_b16 v[162:163], v240 offset:8704
  v_mfma_f32_16x16x32_bf16 v[112:115], v[136:139], v[180:183], v[112:115]
  ds_read_b64_tr_b16 v[164:165], v241 offset:8192
  v_mfma_f32_16x16x32_bf16 v[92:95], v[140:143], v[168:171], v[92:95]
  ds_read_b64_tr_b16 v[166:167], v241 offset:8704
  v_mfma_f32_16x16x32_bf16 v[100:103], v[140:143], v[172:175], v[100:103]
  s_setprio 0
  s_cbranch_vccnz L_skl4_21
  buffer_load_dwordx4 v247, s[28:31], s66 offen offset:3072 lds
L_skl4_21:
  s_add_u32 s66, s66, s69
  s_sub_u32 s70, s70, s73
  v_mfma_f32_16x16x32_bf16 v[108:111], v[140:143], v[176:179], v[108:111]
  v_mfma_f32_16x16x32_bf16 v[116:119], v[140:143], v[180:183], v[116:119]
  s_waitcnt lgkmcnt(0)
  v_mfma_f32_16x16x32_bf16 v[24:27], v[144:147], v[184:187], v[24:27]
  v_mfma_f32_16x16x32_bf16 v[32:35], v[144:147], v[188:191], v[32:35]
  s_waitcnt vmcnt(8)
  s_barrier
  s_setprio 2
  v_mfma_f32_16x16x32_bf16 v[40:43], v[144:147], v[192:195], v[40:43]
  ds_read_b128 v[168:171], v236 offset:0
  v_mfma_f32_16x16x32_bf16 v[48:51], v[144:147], v[196:199], v[48:51]
  ds_read_b64_tr_b16 v[120:121], v240 offset:12288
  v_mfma_f32_16x16x32_bf16 v[28:31], v[148:151], v[184:187], v[28:31]
  s_mov_b32 m0, s70
  s_add_u32 s70, s70, s71
  s_cbranch_vccnz L_skl5_4
  buffer_load_dwordx4 v244, s[28:31], s66 offen offset:0 lds
L_skl5_4:
  v_mfma_f32_16x16x32_bf16 v[36:39], v[148:151], v[188:191], v[36:39]
  ds_read_b64_tr_b16 v[122:123], v240 offset:12800
  v_mfma_f32_16x16x32_bf16 v[44:47], v[148:151], v[192:195], v[44:47]
  ds_read_b128 v[172:175], v236 offset:8192
  v_mfma_f32_16x16x32_bf16 v[52:55], v[148:151], v[196:199], v[52:55]
  ds_read_b128 v[176:179], v236 offset:1024
  v_mfma_f32_16x16x32_bf16 v[56:59], v[152:155], v[184:187], v[56:59]
  ds_read_b128 v[180:183], v236 offset:9216
  v_mfma_f32_16x16x32_bf16 v[64:67], v[152:155], v[188:191], v[64:67]
  ds_read_b64_tr_b16 v[124:125], v241 offset:12288
  v_mfma_f32_16x16x32_bf16 v[72:75], v[152:155], v[192:195], v[72:75]
  s_cbranch_vccnz L_skl5_10
  buffer_load_dwordx4 v245, s[28:31], s66 offen offset:1024 lds
L_skl5_10:
  v_mfma_f32_16x16x32_bf16 v[80:83], v[152:155], v[196:199], v[80:83]
  ds_read_b64_tr_b16 v[126:127], v241 offset:12800
  v_mfma_f32_16x16x32_bf16 v[60:63], v[156:159], v[184:187], v[60:63]
  ds_read_b64_tr_b16 v[128:129], v240 offset:16384
  v_mfma_f32_16x16x32_bf16 v[68:71], v[156:159], v[188:191], v[68:71]
  ds_read_b64_tr_b16 v[130:131], v240 offset:16896
  v_mfma_f32_16x16x32_bf16 v[76:79], v[156:159], v[192:195], v[76:79]
  ds_read_b64_tr_b16 v[132:133], v241 offset:16384
  v_mfma_f32_16x16x32_bf16 v[84:87], v[156:159], v[196:199], v[84:87]
  ds_read_b64_tr_b16 v[134:135], v241 offset:16896
  v_mfma_f32_16x16x32_bf16 v[88:91], v[160:163], v[184:187], v[88:91]
  s_setprio 1
  s_cbranch_vccnz L_skl5_16
  buffer_load_dwordx4 v246, s[28:31], s66 offen offset:2048 lds
L_skl5_16:
  v_mfma_f32_16x16x32_bf16 v[96:99], v[160:163], v[188:191], v[96:99]
  ds_read_b64_tr_b16 v[136:137], v240 offset:20480
  v_mfma_f32_16x16x32_bf16 v[104:107], v[160:163], v[192:195], v[104:107]
  ds_read_b64_tr_b16 v[138:139], v240 offset:20992
  v_mfma_f32_16x16x32_bf16 v[112:115], v[160:163], v[196:199], v[112:115]
  ds_read_b64_tr_b16 v[140:141], v241 offset:20480
  v_mfma_f32_16x16x32_bf16 v[92:95], v[164:167], v[184:187], v[92:95]
  ds_read_b64_tr_b16 v[142:143], v241 offset:20992
  v_mfma_f32_16x16x32_bf16 v[100:103], v[164:167], v[188:191], v[100:103]
  s_setprio 0
  s_cbranch_vccnz L_skl5_21
  buffer_load_dwordx4 v247, s[28:31], s66 offen offset:3072 lds
L_skl5_21:
  s_add_u32 s66, s66, s68
  v_mfma_f32_16x16x32_bf16 v[108:111], v[164:167], v[192:195], v[108:111]
  v_mfma_f32_16x16x32_bf16 v[116:119], v[164:167], v[196:199], v[116:119]
  s_waitcnt lgkmcnt(0)
  v_mfma_f32_16x16x32_bf16 v[24:27], v[120:123], v[168:171], v[24:27]
  v_mfma_f32_16x16x32_bf16 v[32:35], v[120:123], v[172:175], v[32:35]
  s_barrier
  s_setprio 2
  v_mfma_f32_16x16x32_bf16 v[40:43], v[120:123], v[176:179], v[40:43]
  ds_read_b128 v[184:187], v237 offset:0
  v_mfma_f32_16x16x32_bf16 v[48:51], v[120:123], v[180:183], v[48:51]
  ds_read_b64_tr_b16 v[144:145], v240 offset:24576
  v_mfma_f32_16x16x32_bf16 v[28:31], v[124:127], v[168:171], v[28:31]
  s_mov_b32 m0, s70
  s_add_u32 s70, s70, s71
  s_cbranch_vccnz L_skl6_4
  buffer_load_dwordx4 v244, s[28:31], s66 offen offset:0 lds
L_skl6_4:
  v_mfma_f32_16x16x32_bf16 v[36:39], v[124:127], v[172:175], v[36:39]
  ds_read_b64_tr_b16 v[146:147], v240 offset:25088
  v_mfma_f32_16x16x32_bf16 v[44:47], v[124:127], v[176:179], v[44:47]
  ds_read_b128 v[188:191], v237 offset:8192
  v_mfma_f32_16x16x32_bf16 v[52:55], v[124:127], v[180:183], v[52:55]
  ds_read_b128 v[192:195], v237 offset:1024
  v_mfma_f32_16x16x32_bf16 v[56:59], v[128:131], v[168:171], v[56:59]
  ds_read_b128 v[196:199], v237 offset:9216
  v_mfma_f32_16x16x32_bf16 v[64:67], v[128:131], v[172:175], v[64:67]
  ds_read_b64_tr_b16 v[148:149], v241 offset:24576
  v_mfma_f32_16x16x32_bf16 v[72:75], v[128:131], v[176:179], v[72:75]
  s_cbranch_vccnz L_skl6_10
  buffer_load_dwordx4 v245, s[28:31], s66 offen offset:1024 lds
L_skl6_10:
  v_mfma_f32_16x16x32_bf16 v[80:83], v[128:131], v[180:183], v[80:83]
  ds_read_b64_tr_b16 v[150:151], v241 offset:25088
  v_mfma_f32_16x16x32_bf16 v[60:63], v[132:135], v[168:171], v[60:63]
  ds_read_b64_tr_b16 v[152:153], v240 offset:28672
  v_mfma_f32_16x16x32_bf16 v[68:71], v[132:135], v[172:175], v[68:71]
  ds_read_b64_tr_b16 v[154:155], v240 offset:29184
  v_mfma_f32_16x16x32_bf16 v[76:79], v[132:135], v[176:179], v[76:79]
  ds_read_b64_tr_b16 v[156:157], v241 offset:28672
  v_mfma_f32_16x16x32_bf16 v[84:87], v[132:135], v[180:183], v[84:87]
  ds_read_b64_tr_b16 v[158:159], v241 offset:29184
  v_mfma_f32_16x16x32_bf16 v[88:91], v[136:139], v[168:171], v[88:91]
  s_setprio 1
  s_cbranch_vccnz L_skl6_16
  buffer_load_dwordx4 v246, s[28:31], s66 offen offset:2048 lds
L_skl6_16:
  v_mfma_f32_16x16x32_bf16 v[96:99], v[136:139], v[172:175], v[96:99]
  ds_read_b64_tr_b16 v[160:161], v240 offset:32768
  v_mfma_f32_16x16x32_bf16 v[104:107], v[136:139], v[176:179], v[104:107]
  ds_read_b64_tr_b16 v[162:163], v240 offset:33280
  v_mfma_f32_16x16x32_bf16 v[112:115], v[136:139], v[180:183], v[112:115]
  ds_read_b64_tr_b16 v[164:165], v241 offset:32768
  v_mfma_f32_16x16x32_bf16 v[92:95], v[140:143], v[168:171], v[92:95]
  ds_read_b64_tr_b16 v[166:167], v241 offset:33280
  v_mfma_f32_16x16x32_bf16 v[100:103], v[140:143], v[172:175], v[100:103]
  s_setprio 0
  s_cbranch_vccnz L_skl6_21
  buffer_load_dwordx4 v247, s[28:31], s66 offen offset:3072 lds
L_skl6_21:
  s_add_u32 s66, s66, s69
  s_sub_u32 s70, s70, s74
  v_mfma_f32_16x16x32_bf16 v[108:111], v[140:143], v[176:179], v[108:111]
  v_mfma_f32_16x16x32_bf16 v[116:119], v[140:143], v[180:183], v[116:119]
  s_waitcnt lgkmcnt(0)
  v_mfma_f32_16x16x32_bf16 v[24:27], v[144:147], v[184:187], v[24:27]
  v_mfma_f32_16x16x32_bf16 v[32:35], v[144:147], v[188:191], v[32:35]
  s_waitcnt vmcnt(8)
  s_barrier
  s_setprio 2
  v_mfma_f32_16x16x32_bf16 v[40:43], v[144:147], v[192:195], v[40:43]
  ds_read_b128 v[168:171], v236 offset:32768
  v_mfma_f32_16x16x32_bf16 v[48:51], v[144:147], v[196:199], v[48:51]
  ds_read_b64_tr_b16 v[120:121], v240 offset:36864
  v_mfma_f32_16x16x32_bf16 v[28:31], v[148:151], v[184:187], v[28:31]
  s_mov_b32 m0, s70
  s_add_u32 s70, s70, s71
  s_cbranch_vccnz L_skl7_4
  buffer_load_dwordx4 v244, s[28:31], s66 offen offset:0 lds
L_skl7_4:
  v_mfma_f32_16x16x32_bf16 v[36:39], v[148:151], v[188:191], v[36:39]
  ds_read_b64_tr_b16 v[122:123], v240 offset:37376
  v_mfma_f32_16x16x32_bf16 v[44:47], v[148:151], v[192:195], v[44:47]
  ds_read_b128 v[172:175], v236 offset:40960
  v_mfma_f32_16x16x32_bf16 v[52:55], v[148:151], v[196:199], v[52:55]
  ds_read_b128 v[176:179], v236 offset:33792
  v_mfma_f32_16x16x32_bf16 v[56:59], v[152:155], v[184:187], v[56:59]
  ds_read_b128 v[180:183], v236 offset:41984
  v_mfma_f32_16x16x32_bf16 v[64:67], v[152:155], v[188:191], v[64:67]
  ds_read_b64_tr_b16 v[124:125], v241 offset:36864
  v_mfma_f32_16x16x32_bf16 v[72:75], v[152:155], v[192:195], v[72:75]
  s_cbranch_vccnz L_skl7_10
  buffer_load_dwordx4 v245, s[28:31], s66 offen offset:1024 lds
L_skl7_10:
  v_mfma_f32_16x16x32_bf16 v[80:83], v[152:155], v[196:199], v[80:83]
  ds_read_b64_tr_b16 v[126:127], v241 offset:37376
  v_mfma_f32_16x16x32_bf16 v[60:63], v[156:159], v[184:187], v[60:63]
  ds_read_b64_tr_b16 v[128:129], v240 offset:40960
  v_mfma_f32_16x16x32_bf16 v[68:71], v[156:159], v[188:191], v[68:71]
  ds_read_b64_tr_b16 v[130:131], v240 offset:41472
  v_mfma_f32_16x16x32_bf16 v[76:79], v[156:159], v[192:195], v[76:79]
  ds_read_b64_tr_b16 v[132:133], v241 offset:40960
  v_mfma_f32_16x16x32_bf16 v[84:87], v[156:159], v[196:199], v[84:87]
  ds_read_b64_tr_b16 v[134:135], v241 offset:41472
  v_mfma_f32_16x16x32_bf16 v[88:91], v[160:163], v[184:187], v[88:91]
  s_setprio 1
  s_cbranch_vccnz L_skl7_16
  buffer_load_dwordx4 v246, s[28:31], s66 offen offset:2048 lds
L_skl7_16:
  v_mfma_f32_16x16x32_bf16 v[96:99], v[160:163], v[188:191], v[96:99]
  ds_read_b64_tr_b16 v[136:137], v240 offset:45056
  v_mfma_f32_16x16x32_bf16 v[104:107], v[160:163], v[192:195], v[104:107]
  ds_read_b64_tr_b16 v[138:139], v240 offset:45568
  v_mfma_f32_16x16x32_bf16 v[112:115], v[160:163], v[196:199], v[112:115]
  ds_read_b64_tr_b16 v[140:141], v241 offset:45056
  v_mfma_f32_16x16x32_bf16 v[92:95], v[164:167], v[184:187], v[92:95]
  ds_read_b64_tr_b16 v[142:143], v241 offset:45568
  v_mfma_f32_16x16x32_bf16 v[100:103], v[164:167], v[188:191], v[100:103]
  s_setprio 0
  s_cbranch_vccnz L_skl7_21
  buffer_load_dwordx4 v247, s[28:31], s66 offen offset:3072 lds
L_skl7_21:
  s_add_u32 s66, s66, s68
  v_mfma_f32_16x16x32_bf16 v[108:111], v[164:167], v[192:195], v[108:111]
  v_mfma_f32_16x16x32_bf16 v[116:119], v[164:167], v[196:199], v[116:119]
  s_waitcnt lgkmcnt(0)
  v_mfma_f32_16x16x32_bf16 v[24:27], v[120:123], v[168:171], v[24:27]
  s_cmp_ge_u32 s3, 3
  s_cbranch_scc1 L_cs2
  v_mfma_f32_16x16x32_bf16 v[224:227], v[232:235], v[200:203], v[224:227]
  v_mfma_f32_16x16x32_bf16 v[224:227], v[232:235], v[204:207], v[224:227]
  v_mfma_f32_16x16x32_bf16 v[224:227], v[232:235], v[208:211], v[224:227]
  v_mfma_f32_16x16x32_bf16 v[224:227], v[232:235], v[212:215], v[224:227]
L_cs2:
  v_mfma_f32_16x16x32_bf16 v[32:35], v[120:123], v[172:175], v[32:35]
  s_barrier
  s_setprio 2
  v_mfma_f32_16x16x32_bf16 v[40:43], v[120:123], v[176:179], v[40:43]
  ds_read_b128 v[184:187], v237 offset:32768
  v_mfma_f32_16x16x32_bf16 v[48:51], v[120:123], v[180:183], v[48:51]
  ds_read_b64_tr_b16 v[144:145], v240 offset:49152
  v_mfma_f32_16x16x32_bf16 v[28:31], v[124:127], v[168:171], v[28:31]
  s_mov_b32 m0, s70
  s_add_u32 s70, s70, s71
  buffer_load_dwordx4 v244, s[28:31], s66 offen offset:0 lds
  v_mfma_f32_16x16x32_bf16 v[36:39], v[124:127], v[172:175], v[36:39]
  ds_read_b64_tr_b16 v[146:147], v240 offset:49664
  v_mfma_f32_16x16x32_bf16 v[44:47], v[124:127], v[176:179], v[44:47]
  ds_read_b128 v[188:191], v237 offset:40960
  v_mfma_f32_16x16x32_bf16 v[52:55], v[124:127], v[180:183], v[52:55]
  ds_read_b128 v[192:195], v237 offset:33792
  s_cmp_ge_u32 s3, 3
  s_cbranch_scc1 L_c2
  buffer_load_dwordx4 v[200:203], v248, s[28:31], s79 offen offset:3072
  s_add_u32 s79, s79, s67
  buffer_load_dwordx4 v[204:207], v248, s[28:31], s79 offen offset:3072
  s_add_u32 s79, s79, s67
  buffer_load_dwordx4 v[208:211], v248, s[28:31], s79 offen offset:3072
L_c2:
  v_mfma_f32_16x16x32_bf16 v[56:59], v[128:131], v[168:171], v[56:59]
  ds_read_b128 v[196:199], v237 offset:41984
  v_mfma_f32_16x16x32_bf16 v[64:67], v[128:131], v[172:175], v[64:67]
  ds_read_b64_tr_b16 v[148:149], v241 offset:49152
  v_mfma_f32_16x16x32_bf16 v[72:75], v[128:131], v[176:179], v[72:75]
  buffer_load_dwordx4 v245, s[28:31], s66 offen offset:1024 lds
  v_mfma_f32_16x16x32_bf16 v[80:83], v[128:131], v[180:183], v[80:83]
  ds_read_b64_tr_b16 v[150:151], v241 offset:49664
  v_mfma_f32_16x16x32_bf16 v[60:63], v[132:135], v[168:171], v[60:63]
  ds_read_b64_tr_b16 v[152:153], v240 offset:53248
  v_mfma_f32_16x16x32_bf16 v[68:71], v[132:135], v[172:175], v[68:71]
  ds_read_b64_tr_b16 v[154:155], v240 offset:53760
  v_mfma_f32_16x16x32_bf16 v[76:79], v[132:135], v[176:179], v[76:79]
  ds_read_b64_tr_b16 v[156:157], v241 offset:53248
  v_mfma_f32_16x16x32_bf16 v[84:87], v[132:135], v[180:183], v[84:87]
  ds_read_b64_tr_b16 v[158:159], v241 offset:53760
  v_mfma_f32_16x16x32_bf16 v[88:91], v[136:139], v[168:171], v[88:91]
  s_setprio 1
  buffer_load_dwordx4 v246, s[28:31], s66 offen offset:2048 lds
  v_mfma_f32_16x16x32_bf16 v[96:99], v[136:139], v[172:175], v[96:99]
  ds_read_b64_tr_b16 v[160:161], v240 offset:57344
  v_mfma_f32_16x16x32_bf16 v[104:107], v[136:139], v[176:179], v[104:107]
  ds_read_b64_tr_b16 v[162:163], v240 offset:57856
  v_mfma_f32_16x16x32_bf16 v[112:115], v[136:139], v[180:183], v[112:115]
  ds_read_b64_tr_b16 v[164:165], v241 offset:57344
  v_mfma_f32_16x16x32_bf16 v[92:95], v[140:143], v[168:171], v[92:95]
  ds_read_b64_tr_b16 v[166:167], v241 offset:57856
  v_mfma_f32_16x16x32_bf16 v[100:103], v[140:143], v[172:175], v[100:103]
  s_setprio 0
  buffer_load_dwordx4 v247, s[28:31], s66 offen offset:3072 lds
  s_add_u32 s66, s66, s69
  v_mfma_f32_16x16x32_bf16 v[108:111], v[140:143], v[176:179], v[108:111]
  v_mfma_f32_16x16x32_bf16 v[116:119], v[140:143], v[180:183], v[116:119]
  s_waitcnt lgkmcnt(0)
  v_mfma_f32_16x16x32_bf16 v[24:27], v[144:147], v[184:187], v[24:27]
  v_mfma_f32_16x16x32_bf16 v[32:35], v[144:147], v[188:191], v[32:35]
  s_waitcnt vmcnt(8)
  s_barrier
  s_setprio 2
  v_mfma_f32_16x16x32_bf16 v[40:43], v[144:147], v[192:195], v[40:43]
  ds_read_b128 v[168:171], v242 offset:0
  v_mfma_f32_16x16x32_bf16 v[48:51], v[144:147], v[196:199], v[48:51]
  ds_read_b64_tr_b16 v[120:121], v240 offset:0
  v_mfma_f32_16x16x32_bf16 v[28:31], v[148:151], v[184:187], v[28:31]
  s_mov_b32 m0, s70
  s_add_u32 s70, s70, s71
  buffer_load_dwordx4 v244, s[28:31], s66 offen offset:0 lds
  v_mfma_f32_16x16x32_bf16 v[36:39], v[148:151], v[188:191], v[36:39]
  ds_read_b64_tr_b16 v[122:123], v240 offset:512
  v_mfma_f32_16x16x32_bf16 v[44:47], v[148:151], v[192:195], v[44:47]
  ds_read_b128 v[172:175], v242 offset:8192
  v_mfma_f32_16x16x32_bf16 v[52:55], v[148:151], v[196:199], v[52:55]
  ds_read_b128 v[176:179], v242 offset:1024
  buffer_load_dwordx2 v[216:217], v238, s[24:27], s81 offen
  v_mfma_f32_16x16x32_bf16 v[56:59], v[152:155], v[184:187], v[56:59]
  ds_read_b128 v[180:183], v242 offset:9216
  v_mfma_f32_16x16x32_bf16 v[64:67], v[152:155], v[188:191], v[64:67]
  ds_read_b64_tr_b16 v[124:125], v241 offset:0
  v_mfma_f32_16x16x32_bf16 v[72:75], v[152:155], v[192:195], v[72:75]
  buffer_load_dwordx4 v245, s[28:31], s66 offen offset:1024 lds
  v_mfma_f32_16x16x32_bf16 v[80:83], v[152:155], v[196:199], v[80:83]
  ds_read_b64_tr_b16 v[126:127], v241 offset:512
  v_mfma_f32_16x16x32_bf16 v[60:63], v[156:159], v[184:187], v[60:63]
  ds_read_b64_tr_b16 v[128:129], v240 offset:4096
  v_mfma_f32_16x16x32_bf16 v[68:71], v[156:159], v[188:191], v[68:71]
  ds_read_b64_tr_b16 v[130:131], v240 offset:4608
  v_mfma_f32_16x16x32_bf16 v[76:79], v[156:159], v[192:195], v[76:79]
  ds_read_b64_tr_b16 v[132:133], v241 offset:4096
  v_mfma_f32_16x16x32_bf16 v[84:87], v[156:159], v[196:199], v[84:87]
  ds_read_b64_tr_b16 v[134:135], v241 offset:4608
  v_mfma_f32_16x16x32_bf16 v[88:91], v[160:163], v[184:187], v[88:91]
  s_setprio 1
  buffer_load_dwordx4 v246, s[28:31], s66 offen offset:2048 lds
  v_mfma_f32_16x16x32_bf16 v[96:99], v[160:163], v[188:191], v[96:99]
  ds_read_b64_tr_b16 v[136:137], v240 offset:8192
  v_mfma_f32_16x16x32_bf16 v[104:107], v[160:163], v[192:195], v[104:107]
  ds_read_b64_tr_b16 v[138:139], v240 offset:8704
  v_mfma_f32_16x16x32_bf16 v[112:115], v[160:163], v[196:199], v[112:115]
  ds_read_b64_tr_b16 v[140:141], v241 offset:8192
  v_mfma_f32_16x16x32_bf16 v[92:95], v[164:167], v[184:187], v[92:95]
  ds_read_b64_tr_b16 v[142:143], v241 offset:8704
  v_mfma_f32_16x16x32_bf16 v[100:103], v[164:167], v[188:191], v[100:103]
  s_setprio 0
  buffer_load_dwordx4 v247, s[28:31], s66 offen offset:3072 lds
  s_add_u32 s66, s66, s68
  s_sub_u32 s70, s70, s73
  v_mfma_f32_16x16x32_bf16 v[108:111], v[164:167], v[192:195], v[108:111]
  v_mfma_f32_16x16x32_bf16 v[116:119], v[164:167], v[196:199], v[116:119]
  s_waitcnt lgkmcnt(0)
  v_mfma_f32_16x16x32_bf16 v[24:27], v[120:123], v[168:171], v[24:27]
  v_mfma_f32_16x16x32_bf16 v[32:35], v[120:123], v[172:175], v[32:35]
  s_barrier
  s_setprio 2
  v_mfma_f32_16x16x32_bf16 v[40:43], v[120:123], v[176:179], v[40:43]
  ds_read_b128 v[184:187], v243 offset:0
  v_mfma_f32_16x16x32_bf16 v[48:51], v[120:123], v[180:183], v[48:51]
  ds_read_b64_tr_b16 v[144:145], v240 offset:12288
  v_mfma_f32_16x16x32_bf16 v[28:31], v[124:127], v[168:171], v[28:31]
  s_mov_b32 m0, s70
  s_add_u32 s70, s70, s71
  buffer_load_dwordx4 v244, s[28:31], s66 offen offset:0 lds
  v_mfma_f32_16x16x32_bf16 v[36:39], v[124:127], v[172:175], v[36:39]
  ds_read_b64_tr_b16 v[146:147], v240 offset:12800
  v_mfma_f32_16x16x32_bf16 v[44:47], v[124:127], v[176:179], v[44:47]
  ds_read_b128 v[188:191], v243 offset:8192
  v_mfma_f32_16x16x32_bf16 v[52:55], v[124:127], v[180:183], v[52:55]
  ds_read_b128 v[192:195], v243 offset:1024
  v_mfma_f32_16x16x32_bf16 v[56:59], v[128:131], v[168:171], v[56:59]
  ds_read_b128 v[196:199], v243 offset:9216
  v_mfma_f32_16x16x32_bf16 v[64:67], v[128:131], v[172:175], v[64:67]
  ds_read_b64_tr_b16 v[148:149], v241 offset:12288
  v_mfma_f32_16x16x32_bf16 v[72:75], v[128:131], v[176:179], v[72:75]
  buffer_load_dwordx4 v245, s[28:31], s66 offen offset:1024 lds
  v_mfma_f32_16x16x32_bf16 v[80:83], v[128:131], v[180:183], v[80:83]
  ds_read_b64_tr_b16 v[150:151], v241 offset:12800
  v_mfma_f32_16x16x32_bf16 v[60:63], v[132:135], v[168:171], v[60:63]
  ds_read_b64_tr_b16 v[152:153], v240 offset:16384
  v_mfma_f32_16x16x32_bf16 v[68:71], v[132:135], v[172:175], v[68:71]
  ds_read_b64_tr_b16 v[154:155], v240 offset:16896
  v_mfma_f32_16x16x32_bf16 v[76:79], v[132:135], v[176:179], v[76:79]
  ds_read_b64_tr_b16 v[156:157], v241 offset:16384
  v_mfma_f32_16x16x32_bf16 v[84:87], v[132:135], v[180:183], v[84:87]
  ds_read_b64_tr_b16 v[158:159], v241 offset:16896
  v_mfma_f32_16x16x32_bf16 v[88:91], v[136:139], v[168:171], v[88:91]
  s_setprio 1
  buffer_load_dwordx4 v246, s[28:31], s66 offen offset:2048 lds
  v_mfma_f32_16x16x32_bf16 v[96:99], v[136:139], v[172:175], v[96:99]
  ds_read_b64_tr_b16 v[160:161], v240 offset:20480
  v_mfma_f32_16x16x32_bf16 v[104:107], v[136:139], v[176:179], v[104:107]
  ds_read_b64_tr_b16 v[162:163], v240 offset:20992
  v_mfma_f32_16x16x32_bf16 v[112:115], v[136:139], v[180:183], v[112:115]
  ds_read_b64_tr_b16 v[164:165], v241 offset:20480
  v_mfma_f32_16x16x32_bf16 v[92:95], v[140:143], v[168:171], v[92:95]
  ds_read_b64_tr_b16 v[166:167], v241 offset:20992
  v_mfma_f32_16x16x32_bf16 v[100:103], v[140:143], v[172:175], v[100:103]
  s_setprio 0
  buffer_load_dwordx4 v247, s[28:31], s66 offen offset:3072 lds
  s_add_u32 s66, s66, s69
  v_mfma_f32_16x16x32_bf16 v[108:111], v[140:143], v[176:179], v[108:111]
  v_mfma_f32_16x16x32_bf16 v[116:119], v[140:143], v[180:183], v[116:119]
  s_waitcnt lgkmcnt(0)
  v_mfma_f32_16x16x32_bf16 v[24:27], v[144:147], v[184:187], v[24:27]
  s_waitcnt vmcnt(12)
  s_cmp_ge_u32 s3, 3
  s_cbranch_scc1 L_cs3
  v_mfma_f32_16x16x32_bf16 v[224:227], v[232:235], v[200:203], v[224:227]
  v_mfma_f32_16x16x32_bf16 v[224:227], v[232:235], v[204:207], v[224:227]
  v_mfma_f32_16x16x32_bf16 v[224:227], v[232:235], v[208:211], v[224:227]
L_cs3:
  v_mfma_f32_16x16x32_bf16 v[32:35], v[144:147], v[188:191], v[32:35]
  s_waitcnt vmcnt(9)
  s_barrier
  s_setprio 2
  v_mfma_f32_16x16x32_bf16 v[40:43], v[144:147], v[192:195], v[40:43]
  ds_read_b128 v[168:171], v236 offset:0
  v_mfma_f32_16x16x32_bf16 v[48:51], v[144:147], v[196:199], v[48:51]
  ds_read_b64_tr_b16 v[120:121], v240 offset:24576
  v_mfma_f32_16x16x32_bf16 v[28:31], v[148:151], v[184:187], v[28:31]
  s_mov_b32 m0, s70
  s_add_u32 s70, s70, s71
  buffer_load_dwordx4 v244, s[28:31], s66 offen offset:0 lds
  v_mfma_f32_16x16x32_bf16 v[36:39], v[148:151], v[188:191], v[36:39]
  ds_read_b64_tr_b16 v[122:123], v240 offset:25088
  v_mfma_f32_16x16x32_bf16 v[44:47], v[148:151], v[192:195], v[44:47]
  ds_read_b128 v[172:175], v236 offset:8192
  v_mfma_f32_16x16x32_bf16 v[52:55], v[148:151], v[196:199], v[52:55]
  ds_read_b128 v[176:179], v236 offset:1024
  v_mfma_f32_16x16x32_bf16 v[56:59], v[152:155], v[184:187], v[56:59]
  ds_read_b128 v[180:183], v236 offset:9216
  v_mfma_f32_16x16x32_bf16 v[64:67], v[152:155], v[188:191], v[64:67]
  ds_read_b64_tr_b16 v[124:125], v241 offset:24576
  v_mfma_f32_16x16x32_bf16 v[72:75], v[152:155], v[192:195], v[72:75]
  buffer_load_dwordx4 v245, s[28:31], s66 offen offset:1024 lds
  v_mfma_f32_16x16x32_bf16 v[80:83], v[152:155], v[196:199], v[80:83]
  ds_read_b64_tr_b16 v[126:127], v241 offset:25088
  v_mfma_f32_16x16x32_bf16 v[60:63], v[156:159], v[184:187], v[60:63]
  ds_read_b64_tr_b16 v[128:129], v240 offset:28672
  v_add_f32_dpp v224, v224, v224 row_ror:8 row_mask:0xf bank_mask:0xf
  v_mfma_f32_16x16x32_bf16 v[68:71], v[156:159], v[188:191], v[68:71]
  ds_read_b64_tr_b16 v[130:131], v240 offset:29184
  v_add_f32_dpp v225, v225, v225 row_ror:8 row_mask:0xf bank_mask:0xf
  v_mfma_f32_16x16x32_bf16 v[76:79], v[156:159], v[192:195], v[76:79]
  ds_read_b64_tr_b16 v[132:133], v241 offset:28672
  v_add_f32_dpp v226, v226, v226 row_ror:8 row_mask:0xf bank_mask:0xf
  v_mfma_f32_16x16x32_bf16 v[84:87], v[156:159], v[196:199], v[84:87]
  ds_read_b64_tr_b16 v[134:135], v241 offset:29184
  v_add_f32_dpp v227, v227, v227 row_ror:8 row_mask:0xf bank_mask:0xf
  v_mfma_f32_16x16x32_bf16 v[88:91], v[160:163], v[184:187], v[88:91]
  s_setprio 1
  buffer_load_dwordx4 v246, s[28:31], s66 offen offset:2048 lds
  v_cndmask_b32 v224, v224, v225, s[90:91]
  v_mfma_f32_16x16x32_bf16 v[96:99], v[160:163], v[188:191], v[96:99]
  ds_read_b64_tr_b16 v[136:137], v240 offset:32768
  v_cndmask_b32 v226, v226, v227, s[90:91]
  v_mfma_f32_16x16x32_bf16 v[104:107], v[160:163], v[192:195], v[104:107]
  ds_read_b64_tr_b16 v[138:139], v240 offset:33280
  v_mov_b32 v227, v3
  v_mfma_f32_16x16x32_bf16 v[112:115], v[160:163], v[196:199], v[112:115]
  ds_read_b64_tr_b16 v[140:141], v241 offset:32768
  v_cndmask_b32 v224, v224, v226, s[92:93]
  v_mfma_f32_16x16x32_bf16 v[92:95], v[164:167], v[184:187], v[92:95]
  ds_read_b64_tr_b16 v[142:143], v241 offset:33280
  v_cvt_pk_bf16_f32 v225, v224, v224
  v_mfma_f32_16x16x32_bf16 v[100:103], v[164:167], v[188:191], v[100:103]
  s_setprio 0
  buffer_load_dwordx4 v247, s[28:31], s66 offen offset:3072 lds
  s_add_u32 s66, s66, s68
  v_and_b32 v225, 0xffff0000, v225
  v_mfma_f32_16x16x32_bf16 v[108:111], v[164:167], v[192:195], v[108:111]
  v_sub_f32 v224, v224, v225
  v_mfma_f32_16x16x32_bf16 v[116:119], v[164:167], v[196:199], v[116:119]
  v_cvt_pk_bf16_f32 v226, v225, v224
  s_waitcnt lgkmcnt(0)
  v_mfma_f32_16x16x32_bf16 v[24:27], v[120:123], v[168:171], v[24:27]
  v_mfma_f32_16x16x32_bf16 v[32:35], v[120:123], v[172:175], v[32:35]
  s_barrier
  s_setprio 2
  v_mfma_f32_16x16x32_bf16 v[40:43], v[120:123], v[176:179], v[40:43]
  ds_read_b128 v[184:187], v237 offset:0
  v_mfma_f32_16x16x32_bf16 v[48:51], v[120:123], v[180:183], v[48:51]
  ds_read_b64_tr_b16 v[144:145], v240 offset:36864
  v_mfma_f32_16x16x32_bf16 v[28:31], v[124:127], v[168:171], v[28:31]
  s_mov_b32 m0, s70
  s_add_u32 s70, s70, s71
  buffer_load_dwordx4 v244, s[28:31], s66 offen offset:0 lds
  v_mfma_f32_16x16x32_bf16 v[36:39], v[124:127], v[172:175], v[36:39]
  ds_read_b64_tr_b16 v[146:147], v240 offset:37376
  v_mfma_f32_16x16x32_bf16 v[44:47], v[124:127], v[176:179], v[44:47]
  ds_read_b128 v[188:191], v237 offset:8192
  v_mfma_f32_16x16x32_bf16 v[52:55], v[124:127], v[180:183], v[52:55]
  ds_read_b128 v[192:195], v237 offset:1024
  v_mfma_f32_16x16x32_bf16 v[56:59], v[128:131], v[168:171], v[56:59]
  ds_read_b128 v[196:199], v237 offset:9216
  v_mfma_f32_16x16x32_bf16 v[64:67], v[128:131], v[172:175], v[64:67]
  ds_read_b64_tr_b16 v[148:149], v241 offset:36864
  v_mfma_f32_16x16x32_bf16 v[72:75], v[128:131], v[176:179], v[72:75]
  buffer_load_dwordx4 v245, s[28:31], s66 offen offset:1024 lds
  v_mfma_f32_16x16x32_bf16 v[80:83], v[128:131], v[180:183], v[80:83]
  ds_read_b64_tr_b16 v[150:151], v241 offset:37376
  v_mfma_f32_16x16x32_bf16 v[60:63], v[132:135], v[168:171], v[60:63]
  ds_read_b64_tr_b16 v[152:153], v240 offset:40960
  buffer_store_dwordx2 v[226:227], v249, s[24:27], s75 offen sc1
  v_mfma_f32_16x16x32_bf16 v[68:71], v[132:135], v[172:175], v[68:71]
  ds_read_b64_tr_b16 v[154:155], v240 offset:41472
  s_waitcnt vmcnt(14)
  v_cmp_ne_u32 vcc, s36, v217
  v_mfma_f32_16x16x32_bf16 v[76:79], v[132:135], v[176:179], v[76:79]
  ds_read_b64_tr_b16 v[156:157], v241 offset:40960
  s_cbranch_vccnz L_sp_ln
L_sp_ln_done:
  v_mfma_f32_16x16x32_bf16 v[84:87], v[132:135], v[180:183], v[84:87]
  ds_read_b64_tr_b16 v[158:159], v241 offset:41472
  v_mov_b32 v220, v216
  v_mfma_f32_16x16x32_bf16 v[88:91], v[136:139], v[168:171], v[88:91]
  s_setprio 1
  buffer_load_dwordx4 v246, s[28:31], s66 offen offset:2048 lds
  s_mov_b32 s37, 0x01000100
  v_mfma_f32_16x16x32_bf16 v[96:99], v[136:139], v[172:175], v[96:99]
  ds_read_b64_tr_b16 v[160:161], v240 offset:45056
  v_permlane32_swap_b32 v216, v220
  v_mfma_f32_16x16x32_bf16 v[104:107], v[136:139], v[176:179], v[104:107]
  ds_read_b64_tr_b16 v[162:163], v240 offset:45568
  v_mov_b32 v218, v216
  v_mfma_f32_16x16x32_bf16 v[112:115], v[136:139], v[180:183], v[112:115]
  ds_read_b64_tr_b16 v[164:165], v241 offset:45056
  v_mov_b32 v222, v220
  v_mfma_f32_16x16x32_bf16 v[92:95], v[140:143], v[168:171], v[92:95]
  ds_read_b64_tr_b16 v[166:167], v241 offset:45568
  v_permlane16_swap_b32 v216, v218
  v_mfma_f32_16x16x32_bf16 v[100:103], v[140:143], v[172:175], v[100:103]
  s_setprio 0
  buffer_load_dwordx4 v247, s[28:31], s66 offen offset:3072 lds
  s_add_u32 s66, s66, s69
  s_sub_u32 s70, s70, s74
  v_permlane16_swap_b32 v220, v222
  v_mfma_f32_16x16x32_bf16 v[108:111], v[140:143], v[176:179], v[108:111]
  v_and_b32 v16, 0xffff0000, v216
  v_mfma_f32_16x16x32_bf16 v[116:119], v[140:143], v[180:183], v[116:119]
  v_perm_b32 v216, v216, v216, s37
  s_waitcnt lgkmcnt(0)
  v_mfma_f32_16x16x32_bf16 v[24:27], v[144:147], v[184:187], v[24:27]
  v_mfma_f32_16x16x32_bf16 v[32:35], v[144:147], v[188:191], v[32:35]
  s_waitcnt vmcnt(9)
  s_barrier
  s_setprio 2
  v_mfma_f32_16x16x32_bf16 v[40:43], v[144:147], v[192:195], v[40:43]
  ds_read_b128 v[168:171], v236 offset:32768
  v_mfma_f32_16x16x32_bf16 v[48:51], v[144:147], v[196:199], v[48:51]
  ds_read_b64_tr_b16 v[120:121], v240 offset:49152
  v_mfma_f32_16x16x32_bf16 v[28:31], v[148:151], v[184:187], v[28:31]
  s_mov_b32 m0, s70
  s_add_u32 s70, s70, s71
  buffer_load_dwordx4 v244, s[28:31], s66 offen offset:0 lds
  v_mfma_f32_16x16x32_bf16 v[36:39], v[148:151], v[188:191], v[36:39]
  ds_read_b64_tr_b16 v[122:123], v240 offset:49664
  v_mfma_f32_16x16x32_bf16 v[44:47], v[148:151], v[192:195], v[44:47]
  ds_read_b128 v[172:175], v236 offset:40960
  v_mfma_f32_16x16x32_bf16 v[52:55], v[148:151], v[196:199], v[52:55]
  ds_read_b128 v[176:179], v236 offset:33792
  v_mfma_f32_16x16x32_bf16 v[56:59], v[152:155], v[184:187], v[56:59]
  ds_read_b128 v[180:183], v236 offset:41984
  v_mfma_f32_16x16x32_bf16 v[64:67], v[152:155], v[188:191], v[64:67]
  ds_read_b64_tr_b16 v[124:125], v241 offset:49152
  v_mfma_f32_16x16x32_bf16 v[72:75], v[152:155], v[192:195], v[72:75]
  buffer_load_dwordx4 v245, s[28:31], s66 offen offset:1024 lds
  v_mfma_f32_16x16x32_bf16 v[80:83], v[152:155], v[196:199], v[80:83]
  ds_read_b64_tr_b16 v[126:127], v241 offset:49664
  v_mfma_f32_16x16x32_bf16 v[60:63], v[156:159], v[184:187], v[60:63]
  ds_read_b64_tr_b16 v[128:129], v240 offset:53248
  v_rcp_f32 v20, v16
  v_mfma_f32_16x16x32_bf16 v[68:71], v[156:159], v[188:191], v[68:71]
  ds_read_b64_tr_b16 v[130:131], v240 offset:53760
  v_mov_b32 v217, v216
  v_mfma_f32_16x16x32_bf16 v[76:79], v[156:159], v[192:195], v[76:79]
  ds_read_b64_tr_b16 v[132:133], v241 offset:53248
  v_mul_f32 v232, s89, v20
  v_mfma_f32_16x16x32_bf16 v[84:87], v[156:159], v[196:199], v[84:87]
  ds_read_b64_tr_b16 v[134:135], v241 offset:53760
  v_and_b32 v17, 0xffff0000, v218
  v_mfma_f32_16x16x32_bf16 v[88:91], v[160:163], v[184:187], v[88:91]
  s_setprio 1
  buffer_load_dwordx4 v246, s[28:31], s66 offen offset:2048 lds
  v_perm_b32 v218, v218, v218, s37
  v_mfma_f32_16x16x32_bf16 v[96:99], v[160:163], v[188:191], v[96:99]
  ds_read_b64_tr_b16 v[136:137], v240 offset:57344
  v_rcp_f32 v21, v17
  v_mfma_f32_16x16x32_bf16 v[104:107], v[160:163], v[192:195], v[104:107]
  ds_read_b64_tr_b16 v[138:139], v240 offset:57856
  v_mov_b32 v219, v218
  v_mfma_f32_16x16x32_bf16 v[112:115], v[160:163], v[196:199], v[112:115]
  ds_read_b64_tr_b16 v[140:141], v241 offset:57344
  v_mul_f32 v233, s89, v21
  v_mfma_f32_16x16x32_bf16 v[92:95], v[164:167], v[184:187], v[92:95]
  ds_read_b64_tr_b16 v[142:143], v241 offset:57856
  v_and_b32 v18, 0xffff0000, v220
  v_mfma_f32_16x16x32_bf16 v[100:103], v[164:167], v[188:191], v[100:103]
  s_setprio 0
  buffer_load_dwordx4 v247, s[28:31], s66 offen offset:3072 lds
  s_add_u32 s66, s66, s68
  v_perm_b32 v220, v220, v220, s37
  v_mfma_f32_16x16x32_bf16 v[108:111], v[164:167], v[192:195], v[108:111]
  v_rcp_f32 v22, v18
  v_mfma_f32_16x16x32_bf16 v[116:119], v[164:167], v[196:199], v[116:119]
  v_mov_b32 v221, v220
  s_waitcnt lgkmcnt(0)
  v_mfma_f32_16x16x32_bf16 v[24:27], v[120:123], v[168:171], v[24:27]
  v_mfma_f32_16x16x32_bf16 v[32:35], v[120:123], v[172:175], v[32:35]
  s_barrier
  s_setprio 2
  v_mfma_f32_16x16x32_bf16 v[40:43], v[120:123], v[176:179], v[40:43]
  ds_read_b128 v[184:187], v237 offset:32768
  v_mfma_f32_16x16x32_bf16 v[48:51], v[120:123], v[180:183], v[48:51]
  ds_read_b64_tr_b16 v[144:145], v240 offset:0
  v_mfma_f32_16x16x32_bf16 v[28:31], v[124:127], v[168:171], v[28:31]
  s_mov_b32 m0, s70
  s_add_u32 s70, s70, s71
  buffer_load_dwordx4 v244, s[28:31], s66 offen offset:0 lds
  v_mfma_f32_16x16x32_bf16 v[36:39], v[124:127], v[172:175], v[36:39]
  ds_read_b64_tr_b16 v[146:147], v240 offset:512
  v_mfma_f32_16x16x32_bf16 v[44:47], v[124:127], v[176:179], v[44:47]
  ds_read_b128 v[188:191], v237 offset:40960
  v_mfma_f32_16x16x32_bf16 v[52:55], v[124:127], v[180:183], v[52:55]
  ds_read_b128 v[192:195], v237 offset:33792
  v_mfma_f32_16x16x32_bf16 v[56:59], v[128:131], v[168:171], v[56:59]
  ds_read_b128 v[196:199], v237 offset:41984
  v_mfma_f32_16x16x32_bf16 v[64:67], v[128:131], v[172:175], v[64:67]
  ds_read_b64_tr_b16 v[148:149], v241 offset:0
  v_mfma_f32_16x16x32_bf16 v[72:75], v[128:131], v[176:179], v[72:75]
  buffer_load_dwordx4 v245, s[28:31], s66 offen offset:1024 lds
  v_mfma_f32_16x16x32_bf16 v[80:83], v[128:131], v[180:183], v[80:83]
  ds_read_b64_tr_b16 v[150:151], v241 offset:512
  v_mfma_f32_16x16x32_bf16 v[60:63], v[132:135], v[168:171], v[60:63]
  ds_read_b64_tr_b16 v[152:153], v240 offset:4096
  v_mul_f32 v234, s89, v22
  v_mfma_f32_16x16x32_bf16 v[68:71], v[132:135], v[172:175], v[68:71]
  ds_read_b64_tr_b16 v[154:155], v240 offset:4608
  v_and_b32 v19, 0xffff0000, v222
  v_mfma_f32_16x16x32_bf16 v[76:79], v[132:135], v[176:179], v[76:79]
  ds_read_b64_tr_b16 v[156:157], v241 offset:4096
  v_perm_b32 v222, v222, v222, s37
  v_mfma_f32_16x16x32_bf16 v[84:87], v[132:135], v[180:183], v[84:87]
  ds_read_b64_tr_b16 v[158:159], v241 offset:4608
  v_rcp_f32 v23, v19
  v_mfma_f32_16x16x32_bf16 v[88:91], v[136:139], v[168:171], v[88:91]
  s_setprio 1
  buffer_load_dwordx4 v246, s[28:31], s66 offen offset:2048 lds
  v_mov_b32 v223, v222
  v_mfma_f32_16x16x32_bf16 v[96:99], v[136:139], v[172:175], v[96:99]
  ds_read_b64_tr_b16 v[160:161], v240 offset:8192
  v_mul_f32 v235, s89, v23
  v_mfma_f32_16x16x32_bf16 v[104:107], v[136:139], v[176:179], v[104:107]
  ds_read_b64_tr_b16 v[162:163], v240 offset:8704
  v_mfma_f32_16x16x32_bf16 v[112:115], v[136:139], v[180:183], v[112:115]
  ds_read_b64_tr_b16 v[164:165], v241 offset:8192
  v_mfma_f32_16x16x32_bf16 v[92:95], v[140:143], v[168:171], v[92:95]
  ds_read_b64_tr_b16 v[166:167], v241 offset:8704
  v_mfma_f32_16x16x32_bf16 v[100:103], v[140:143], v[172:175], v[100:103]
  s_setprio 0
  buffer_load_dwordx4 v247, s[28:31], s66 offen offset:3072 lds
  s_add_u32 s66, s66, s69
  s_sub_u32 s70, s70, s73
  v_mfma_f32_16x16x32_bf16 v[108:111], v[140:143], v[176:179], v[108:111]
  v_mfma_f32_16x16x32_bf16 v[116:119], v[140:143], v[180:183], v[116:119]
  s_waitcnt lgkmcnt(0)
  v_mfma_f32_16x16x32_bf16 v[24:27], v[144:147], v[184:187], v[24:27]
  v_mfma_f32_16x16x32_bf16 v[32:35], v[144:147], v[188:191], v[32:35]
  s_waitcnt vmcnt(8)
  s_barrier
  s_setprio 2
  v_mfma_f32_16x16x32_bf16 v[40:43], v[144:147], v[192:195], v[40:43]
  ds_read_b128 v[168:171], v242 offset:0
  v_mfma_f32_16x16x32_bf16 v[48:51], v[144:147], v[196:199], v[48:51]
  ds_read_b64_tr_b16 v[120:121], v240 offset:12288
  buffer_load_dwordx4 v[224:227], v239, s[24:27], s83 offen offset:0
  v_mfma_f32_16x16x32_bf16 v[28:31], v[148:151], v[184:187], v[28:31]
  ds_read_b64_tr_b16 v[122:123], v240 offset:12800
  v_mfma_f32_16x16x32_bf16 v[36:39], v[148:151], v[188:191], v[36:39]
  ds_read_b128 v[172:175], v242 offset:8192
  v_mfma_f32_16x16x32_bf16 v[44:47], v[148:151], v[192:195], v[44:47]
  ds_read_b128 v[176:179], v242 offset:1024
  v_mfma_f32_16x16x32_bf16 v[52:55], v[148:151], v[196:199], v[52:55]
  ds_read_b128 v[180:183], v242 offset:9216
  v_mfma_f32_16x16x32_bf16 v[56:59], v[152:155], v[184:187], v[56:59]
  ds_read_b64_tr_b16 v[124:125], v241 offset:12288
  v_mfma_f32_16x16x32_bf16 v[64:67], v[152:155], v[188:191], v[64:67]
  ds_read_b64_tr_b16 v[126:127], v241 offset:12800
  buffer_load_dwordx4 v[228:231], v239, s[24:27], s83 offen offset:256
  v_mfma_f32_16x16x32_bf16 v[72:75], v[152:155], v[192:195], v[72:75]
  ds_read_b64_tr_b16 v[128:129], v240 offset:16384
  v_mfma_f32_16x16x32_bf16 v[80:83], v[152:155], v[196:199], v[80:83]
  ds_read_b64_tr_b16 v[130:131], v240 offset:16896
  v_mfma_f32_16x16x32_bf16 v[60:63], v[156:159], v[184:187], v[60:63]
  ds_read_b64_tr_b16 v[132:133], v241 offset:16384
  v_mfma_f32_16x16x32_bf16 v[68:71], v[156:159], v[188:191], v[68:71]
  ds_read_b64_tr_b16 v[134:135], v241 offset:16896
  v_mfma_f32_16x16x32_bf16 v[76:79], v[156:159], v[192:195], v[76:79]
  ds_read_b64_tr_b16 v[136:137], v240 offset:20480
  v_mfma_f32_16x16x32_bf16 v[84:87], v[156:159], v[196:199], v[84:87]
  ds_read_b64_tr_b16 v[138:139], v240 offset:20992
  v_mfma_f32_16x16x32_bf16 v[88:91], v[160:163], v[184:187], v[88:91]
  s_setprio 1
  ds_read_b64_tr_b16 v[140:141], v241 offset:20480
  v_mfma_f32_16x16x32_bf16 v[96:99], v[160:163], v[188:191], v[96:99]
  ds_read_b64_tr_b16 v[142:143], v241 offset:20992
  v_mfma_f32_16x16x32_bf16 v[104:107], v[160:163], v[192:195], v[104:107]
  v_mfma_f32_16x16x32_bf16 v[112:115], v[160:163], v[196:199], v[112:115]
  v_mfma_f32_16x16x32_bf16 v[92:95], v[164:167], v[184:187], v[92:95]
  v_mfma_f32_16x16x32_bf16 v[100:103], v[164:167], v[188:191], v[100:103]
  s_setprio 0
  v_mfma_f32_16x16x32_bf16 v[108:111], v[164:167], v[192:195], v[108:111]
  v_mfma_f32_16x16x32_bf16 v[116:119], v[164:167], v[196:199], v[116:119]
  s_setprio 3
  ds_read_b64_tr_b16 v[144:145], v240 offset:24576
  ds_read_b64_tr_b16 v[146:147], v240 offset:25088
  ds_read_b128 v[184:187], v243 offset:0
  ds_read_b128 v[188:191], v243 offset:8192
  s_waitcnt lgkmcnt(4)
  v_mfma_f32_16x16x32_bf16 v[24:27], v[120:123], v[168:171], v[24:27]
  ds_read_b128 v[192:195], v243 offset:1024
  ds_read_b128 v[196:199], v243 offset:9216
  v_mfma_f32_16x16x32_bf16 v[32:35], v[120:123], v[172:175], v[32:35]
  ds_read_b64_tr_b16 v[148:149], v241 offset:24576
  ds_read_b64_tr_b16 v[150:151], v241 offset:25088
  v_mfma_f32_16x16x32_bf16 v[40:43], v[120:123], v[176:179], v[40:43]
  v_mfma_f32_16x16x32_bf16 v[48:51], v[120:123], v[180:183], v[48:51]
  v_mfma_f32_16x16x32_bf16 v[28:31], v[124:127], v[168:171], v[28:31]
  v_mfma_f32_16x16x32_bf16 v[36:39], v[124:127], v[172:175], v[36:39]
  v_mfma_f32_16x16x32_bf16 v[44:47], v[124:127], v[176:179], v[44:47]
  v_mfma_f32_16x16x32_bf16 v[52:55], v[124:127], v[180:183], v[52:55]
  s_waitcnt lgkmcnt(0)
  v_mfma_f32_16x16x32_bf16 v[24:27], v[144:147], v[184:187], v[24:27]
  s_waitcnt vmcnt(0)
  s_barrier
  ds_read_b64_tr_b16 v[120:121], v240 offset:36864
  ds_read_b64_tr_b16 v[122:123], v240 offset:37376
  v_xor_b32 v225, s36, v225
  v_mfma_f32_16x16x32_bf16 v[32:35], v[144:147], v[188:191], v[32:35]
  ds_read_b128 v[152:155], v236 offset:0
  ds_read_b128 v[156:159], v236 offset:8192
  v_bitop3_b32 v225, v225, v227, s36 bitop3:0xf6
  v_mfma_f32_16x16x32_bf16 v[40:43], v[144:147], v[192:195], v[40:43]
  ds_read_b128 v[160:163], v236 offset:1024
  ds_read_b128 v[164:167], v236 offset:9216
  v_bitop3_b32 v225, v225, v229, s36 bitop3:0xf6
  v_mfma_f32_16x16x32_bf16 v[48:51], v[144:147], v[196:199], v[48:51]
  ds_read_b64_tr_b16 v[124:125], v241 offset:36864
  ds_read_b64_tr_b16 v[126:127], v241 offset:37376
  v_bitop3_b32 v225, v225, v231, s36 bitop3:0xf6
  v_mfma_f32_16x16x32_bf16 v[28:31], v[148:151], v[184:187], v[28:31]
  ds_read_b128 v[200:203], v237 offset:0
  ds_read_b128 v[204:207], v237 offset:8192
  v_cmp_ne_u32 vcc, 0, v225
  v_mfma_f32_16x16x32_bf16 v[36:39], v[148:151], v[188:191], v[36:39]
  ds_read_b128 v[208:211], v237 offset:1024
  ds_read_b128 v[212:215], v237 offset:9216
  s_cbranch_vccnz L_sp_st
L_sp_st_done:
  v_mfma_f32_16x16x32_bf16 v[44:47], v[148:151], v[192:195], v[44:47]
  v_mov_b32 v225, v226
  v_mfma_f32_16x16x32_bf16 v[52:55], v[148:151], v[196:199], v[52:55]
  v_mov_b32 v229, v230
  ds_read_b64_tr_b16 v[144:145], v240 offset:49152
  ds_read_b64_tr_b16 v[146:147], v240 offset:49664
  ds_read_b64_tr_b16 v[148:149], v241 offset:49152
  ds_read_b64_tr_b16 v[150:151], v241 offset:49664
  v_mfma_f32_16x16x16_bf16 v[24:27], v[224:225], v[216:217], v[24:27]
  v_mfma_f32_16x16x16_bf16 v[28:31], v[228:229], v[216:217], v[28:31]
  v_mfma_f32_16x16x16_bf16 v[32:35], v[224:225], v[218:219], v[32:35]
  v_mfma_f32_16x16x16_bf16 v[36:39], v[228:229], v[218:219], v[36:39]
  v_mfma_f32_16x16x16_bf16 v[40:43], v[224:225], v[220:221], v[40:43]
  v_mfma_f32_16x16x16_bf16 v[44:47], v[228:229], v[220:221], v[44:47]
  v_mfma_f32_16x16x16_bf16 v[48:51], v[224:225], v[222:223], v[48:51]
  v_mfma_f32_16x16x16_bf16 v[52:55], v[228:229], v[222:223], v[52:55]
  buffer_load_dwordx4 v[224:227], v239, s[24:27], s84 offen offset:0
  buffer_load_dwordx4 v[228:231], v239, s[24:27], s84 offen offset:256
  s_waitcnt lgkmcnt(0)
  v_mfma_f32_16x16x32_bf16 v[24:27], v[120:123], v[152:155], v[24:27]
  v_mfma_f32_16x16x32_bf16 v[32:35], v[120:123], v[156:159], v[32:35]
  v_mfma_f32_16x16x32_bf16 v[24:27], v[144:147], v[200:203], v[24:27]
  v_mfma_f32_16x16x32_bf16 v[32:35], v[144:147], v[204:207], v[32:35]
  v_mfma_f32_16x16x32_bf16 v[28:31], v[124:127], v[152:155], v[28:31]
  v_mfma_f32_16x16x32_bf16 v[36:39], v[124:127], v[156:159], v[36:39]
  v_mfma_f32_16x16x32_bf16 v[28:31], v[148:151], v[200:203], v[28:31]
  v_mfma_f32_16x16x32_bf16 v[36:39], v[148:151], v[204:207], v[36:39]
  s_nop 2
  v_mul_f32 v24, v232, v24
  v_mul_f32 v25, v232, v25
  v_mul_f32 v26, v232, v26
  v_mfma_f32_16x16x32_bf16 v[40:43], v[120:123], v[160:163], v[40:43]
  v_mul_f32 v27, v232, v27
  v_mul_f32 v32, v233, v32
  v_mul_f32 v33, v233, v33
  v_mfma_f32_16x16x32_bf16 v[48:51], v[120:123], v[164:167], v[48:51]
  v_mul_f32 v34, v233, v34
  v_mul_f32 v35, v233, v35
  v_cvt_pk_bf16_f32 v24, v24, v25
  v_mfma_f32_16x16x32_bf16 v[40:43], v[144:147], v[208:211], v[40:43]
  v_cvt_pk_bf16_f32 v25, v26, v27
  v_cvt_pk_bf16_f32 v26, v32, v33
  v_cvt_pk_bf16_f32 v27, v34, v35
  v_mfma_f32_16x16x32_bf16 v[48:51], v[144:147], v[212:215], v[48:51]
  v_mul_f32 v28, v232, v28
  v_mul_f32 v29, v232, v29
  v_permlane16_swap_b32 v24, v26
  v_mfma_f32_16x16x32_bf16 v[44:47], v[124:127], v[160:163], v[44:47]
  v_permlane16_swap_b32 v25, v27
  buffer_store_dwordx4 v[24:27], v2, s[24:27], s86 offen offset:0 sc1
  v_mul_f32 v30, v232, v30
  v_mfma_f32_16x16x32_bf16 v[52:55], v[124:127], v[164:167], v[52:55]
  v_mul_f32 v31, v232, v31
  v_mul_f32 v36, v233, v36
  v_mul_f32 v37, v233, v37
  v_mfma_f32_16x16x32_bf16 v[44:47], v[148:151], v[208:211], v[44:47]
  v_mul_f32 v38, v233, v38
  v_mul_f32 v39, v233, v39
  v_cvt_pk_bf16_f32 v28, v28, v29
  v_mfma_f32_16x16x32_bf16 v[52:55], v[148:151], v[212:215], v[52:55]
  v_cvt_pk_bf16_f32 v29, v30, v31
  v_cvt_pk_bf16_f32 v30, v36, v37
  v_cvt_pk_bf16_f32 v31, v38, v39
  ds_read_b64_tr_b16 v[120:121], v240 offset:28672
  ds_read_b64_tr_b16 v[122:123], v240 offset:29184
  ds_read_b64_tr_b16 v[124:125], v241 offset:28672
  ds_read_b64_tr_b16 v[126:127], v241 offset:29184
  ds_read_b64_tr_b16 v[144:145], v240 offset:40960
  ds_read_b64_tr_b16 v[146:147], v240 offset:41472
  ds_read_b64_tr_b16 v[148:149], v241 offset:40960
  ds_read_b64_tr_b16 v[150:151], v241 offset:41472
  v_mul_f32 v40, v234, v40
  v_mul_f32 v41, v234, v41
  v_mfma_f32_16x16x32_bf16 v[56:59], v[128:131], v[168:171], v[56:59]
  v_permlane16_swap_b32 v28, v30
  v_permlane16_swap_b32 v29, v31
  v_mfma_f32_16x16x32_bf16 v[64:67], v[128:131], v[172:175], v[64:67]
  buffer_store_dwordx4 v[28:31], v2, s[24:27], s86 offen offset:1024 sc1
  v_mul_f32 v42, v234, v42
  v_mfma_f32_16x16x32_bf16 v[72:75], v[128:131], v[176:179], v[72:75]
  v_mul_f32 v43, v234, v43
  v_mul_f32 v48, v235, v48
  v_mfma_f32_16x16x32_bf16 v[80:83], v[128:131], v[180:183], v[80:83]
  v_mul_f32 v49, v235, v49
  v_mul_f32 v50, v235, v50
  v_mfma_f32_16x16x32_bf16 v[60:63], v[132:135], v[168:171], v[60:63]
  v_mul_f32 v51, v235, v51
  v_cvt_pk_bf16_f32 v40, v40, v41
  v_mfma_f32_16x16x32_bf16 v[68:71], v[132:135], v[172:175], v[68:71]
  v_cvt_pk_bf16_f32 v41, v42, v43
  v_cvt_pk_bf16_f32 v42, v48, v49
  v_mfma_f32_16x16x32_bf16 v[76:79], v[132:135], v[176:179], v[76:79]
  v_cvt_pk_bf16_f32 v43, v50, v51
  v_mul_f32 v44, v234, v44
  v_mfma_f32_16x16x32_bf16 v[84:87], v[132:135], v[180:183], v[84:87]
  v_mul_f32 v45, v234, v45
  v_permlane16_swap_b32 v40, v42
  v_permlane16_swap_b32 v41, v43
  buffer_store_dwordx4 v[40:43], v2, s[24:27], s87 offen offset:0 sc1
  v_mul_f32 v46, v234, v46
  v_mul_f32 v47, v234, v47
  v_mul_f32 v52, v235, v52
  v_mul_f32 v53, v235, v53
  v_mul_f32 v54, v235, v54
  v_mul_f32 v55, v235, v55
  v_cvt_pk_bf16_f32 v44, v44, v45
  v_cvt_pk_bf16_f32 v45, v46, v47
  v_cvt_pk_bf16_f32 v46, v52, v53
  v_cvt_pk_bf16_f32 v47, v54, v55
  ds_read_b64_tr_b16 v[32:33], v240 offset:53248
  ds_read_b64_tr_b16 v[34:35], v240 offset:53760
  v_permlane16_swap_b32 v44, v46
  v_permlane16_swap_b32 v45, v47
  ds_read_b64_tr_b16 v[36:37], v241 offset:53248
  ds_read_b64_tr_b16 v[38:39], v241 offset:53760
  buffer_store_dwordx4 v[44:47], v2, s[24:27], s87 offen offset:1024 sc1
  s_setprio 3
  s_and_b32 s70, s2, 7
  s_lshr_b32 s69, s2, 6
  s_lshl2_add_u32 s70, s70, s69
  s_and_b32 s74, s70, 1
  s_mul_i32 s69, s70, 5
  s_lshr_b32 s69, s69, 1
  s_add_u32 s71, s69, s74
  s_add_u32 s66, s69, 2
  s_sub_u32 s73, s66, s74
  s_sub_u32 s73, s73, s74
  s_lshl_b32 s71, s71, 9
  s_lshl_b32 s73, s73, 9
  s_lshl_b32 s74, s74, 3
  s_lshr_b32 s69, s69, 2
  s_lshr_b32 s66, s66, 2
  s_sub_u32 s66, s66, s69
  v_lshrrev_b32 v244, 5, v1
  v_and_b32 v245, 31, v1
  v_and_b32 v246, s66, v244
  v_add_lshl_u32 v246, s69, v246, 10
  v_lshl_add_u32 v12, v245, 5, v246
  v_lshlrev_b32 v245, 4, v245
  s_mov_b32 s69, 122880
  v_mad_u32_u24 v10, v244, s69, v245
  s_xor_b32 s66, s40, 1
  v_xor_b32 v11, s66, v244
  v_mad_u32_u24 v11, v11, s69, v245
  s_lshr_b32 s69, s39, 1
  s_and_b32 s66, s39, 1
  s_mul_i32 s45, s69, 6336
  s_mul_i32 s42, s40, 12800
  s_add_u32 s45, s45, s42
  s_lshl_b32 s42, s66, 10
  s_add_u32 s45, s45, s42
  s_lshl4_add_u32 s66, s40, s66
  s_mul_i32 s66, s66, 6
  s_add_u32 s66, s66, s69
  s_add_u32 s66, s66, 1
  s_mul_i32 s66, s66, 40960
  s_add_u32 s42, s66, s71
  s_add_u32 s43, s66, s73
  s_bfe_u32 s66, s2, 0x30003
  s_lshl2_add_u32 s66, s66, s39
  s_add_u32 s73, s73, s74
  s_mul_i32 s50, s66, 245760
  s_add_u32 s50, s50, s73
  s_lshl1_add_u32 s66, s66, s40
  s_xor_b32 s69, s66, 1
  s_mul_i32 s48, s66, 122880
  s_mul_i32 s49, s69, 122880
  s_add_u32 s48, s48, s71
  s_add_u32 s49, s49, s71
  s_mul_i32 s37, s40, 12800
  s_add_u32 s37, s37, 81920
  v_lshrrev_b32 v244, 5, v1
  v_and_b32 v245, 0x1f0, v2
  v_mul_u32_u24 v5, 2112, v244
  v_add3_u32 v5, v5, v245, s37
  s_add_u32 s38, s74, s37
  s_add_u32 s38, s38, 4224
  v_add_u32 v6, s38, v245
  v_bfe_u32 v245, v1, 2, 2
  v_lshl_add_u32 v245, v244, 3, v245
  v_and_b32 v246, 1, v1
  v_mul_u32_u24 v246, 2112, v246
  v_bfe_u32 v247, v1, 1, 1
  v_lshlrev_b32 v247, 3, v247
  s_add_u32 s37, s37, 6336
  v_add3_u32 v246, v247, v246, s37
  s_add_u32 s38, s38, 6336
  v_mov_b32 v249, s38
  v_and_b32 v248, 19, v1
  v_cmp_eq_u32 vcc, 16, v248
  v_add_u32 v247, 158848, v247
  v_mov_b32 v4, 0xdddddddd
  v_cndmask_b32 v246, v246, v249, vcc
  v_cmp_lt_u32 vcc, 16, v248
  s_nop 1
  v_cndmask_b32 v246, v246, v247, vcc
  v_cndmask_b32 v8, 1, 0, vcc
  v_lshl_add_u32 v7, v245, 4, v246
  s_lshl1_add_u32 s61, s65, s40
  s_cmp_lt_u32 s65, 27
  s_cselect_b32 s61, s61, 63
  s_lshr_b32 s69, s2, 6
  s_xor_b32 s69, s69, s39
  s_lshl2_add_u32 s69, s64, s69
  s_lshl_b32 s69, s69, 8
  s_lshl2_add_u32 s61, s61, s69
  s_add_u32 s61, s61, 21241856
  s_mul_i32 s69, s66, 40960
  s_add_u32 s69, s69, 14942208
  s_add_u32 s52, s69, s73
  s_add_u32 s51, s69, s71
  s_lshl_b32 s53, s66, 5
  s_add_u32 s53, s53, s70
  s_lshl_b32 s53, s53, 2
  s_add_u32 s53, s53, 21254144
  s_bfe_u32 s71, s2, 0x20001
  s_bfe_u32 s69, s2, 0x30003
  s_lshl3_add_u32 s71, s71, s69
  s_and_b32 s73, s2, 1
  s_lshr_b32 s69, s2, 6
  s_lshl2_add_u32 s73, s73, s69
  s_lshl1_add_u32 s69, s73, s40
  s_lshl_b32 s59, s69, 8
  s_add_u32 s59, s59, 21250048
  s_mul_i32 s69, s69, 37
  s_add_u32 s69, s69, s39
  s_mul_i32 s56, s69, 5120
  s_add_u32 s56, s56, 17563648
  s_lshl_b32 s58, s71, 8
  s_mul_i32 s69, s40, 108
  s_add_u32 s58, s58, s69
  s_add_u32 s58, s58, 21241856
  s_mul_i32 s57, s71, 81920
  s_mul_i32 s69, s73, 160
  s_add_u32 s57, s57, s69
  s_lshr_b32 s69, s39, 1
  s_lshl1_add_u32 s71, s71, s69
  s_lshl1_add_u32 s71, s71, s40
  s_and_b32 s69, s39, 1
  s_lshl_b32 s69, s69, 8
  s_mul_i32 s54, s71, 55296
  s_add_u32 s54, s54, s69
  s_add_u32 s54, s54, 7864320
  s_mul_i32 s55, s71, 20480
  s_add_u32 s55, s55, s69
  s_add_u32 s55, s55, 14942208
  s_lshr_b32 s60, s71, 2
  s_lshl_b32 s60, s60, 8
  s_add_u32 s60, s60, 21254144
  s_mul_i32 s63, s3, 5120
  v_add_u32 v246, 0, v0
  v_mul_u32_u24 v247, 3277, v246
  v_lshrrev_b32 v247, 16, v247
  v_bfe_u32 v248, v247, 1, 2
  v_xor_b32 v246, v246, v248
  v_mul_u32_u24 v247, 1120, v247
  v_lshl_add_u32 v253, v246, 3, v247
  v_add_u32 v246, 512, v0
  v_mul_u32_u24 v247, 3277, v246
  v_lshrrev_b32 v247, 16, v247
  v_bfe_u32 v248, v247, 1, 2
  v_xor_b32 v246, v246, v248
  v_mul_u32_u24 v247, 1120, v247
  v_lshl_add_u32 v254, v246, 3, v247
  v_lshrrev_b32 v246, 1, v0
  v_add_u32 v246, 1024, v246
  v_mul_u32_u24 v247, 3277, v246
  v_lshrrev_b32 v247, 16, v247
  v_bfe_u32 v248, v247, 1, 2
  v_xor_b32 v246, v246, v248
  v_mul_u32_u24 v247, 1120, v247
  v_lshl_add_u32 v255, v246, 3, v247
  v_and_b32 v246, 1, v0
  v_lshl_add_u32 v255, v246, 2, v255
  v_lshrrev_b32 v246, 4, v1
  v_bfe_u32 v247, v1, 1, 2
  v_xor_b32 v246, v246, v247
  v_and_b32 v247, 15, v1
  v_mul_u32_u24 v14, 320, v247
  v_lshl_add_u32 v14, v246, 4, v14
  s_add_u32 s37, s63, 40960
  v_add_u32 v14, s37, v14
  s_waitcnt vmcnt(0)
  s_mov_b64 exec, 1
  buffer_store_dword v3, off, s[24:27], s88 offset:0 sc1
  s_mov_b64 exec, -1
  v_xor_b32 v225, s36, v225
  v_bitop3_b32 v225, v225, v227, s36 bitop3:0xf6
  v_bitop3_b32 v225, v225, v229, s36 bitop3:0xf6
  v_bitop3_b32 v225, v225, v231, s36 bitop3:0xf6
  v_cmp_ne_u32 vcc, 0, v225
  s_cbranch_vccnz L_sp_g
L_sp_g_done:
  v_mov_b32 v225, v226
  v_mov_b32 v229, v230
  s_mov_b32 s68, 0xbdd2d3e8
  v_mov_b32 v236, 0xc0135761
  v_mfma_f32_16x16x16_bf16 v[56:59], v[224:225], v[216:217], v[56:59]
  ds_read_b64_tr_b16 v[48:49], v240 offset:32768
  ds_read_b64_tr_b16 v[50:51], v240 offset:33280
  ds_read_b64_tr_b16 v[52:53], v241 offset:32768
  ds_read_b64_tr_b16 v[54:55], v241 offset:33280
  v_mfma_f32_16x16x16_bf16 v[60:63], v[228:229], v[216:217], v[60:63]
  v_mfma_f32_16x16x16_bf16 v[64:67], v[224:225], v[218:219], v[64:67]
  ds_read_b64_tr_b16 v[40:41], v240 offset:45056
  ds_read_b64_tr_b16 v[42:43], v240 offset:45568
  ds_read_b64_tr_b16 v[44:45], v241 offset:45056
  ds_read_b64_tr_b16 v[46:47], v241 offset:45568
  v_mfma_f32_16x16x16_bf16 v[68:71], v[228:229], v[218:219], v[68:71]
  v_mfma_f32_16x16x16_bf16 v[72:75], v[224:225], v[220:221], v[72:75]
  v_mfma_f32_16x16x16_bf16 v[76:79], v[228:229], v[220:221], v[76:79]
  v_mfma_f32_16x16x16_bf16 v[80:83], v[224:225], v[222:223], v[80:83]
  v_mfma_f32_16x16x16_bf16 v[84:87], v[228:229], v[222:223], v[84:87]
  buffer_load_dwordx4 v[224:227], v239, s[24:27], s85 offen offset:0
  buffer_load_dwordx4 v[228:231], v239, s[24:27], s85 offen offset:256
  s_waitcnt lgkmcnt(8)
  v_mfma_f32_16x16x32_bf16 v[56:59], v[120:123], v[184:187], v[56:59]
  v_mfma_f32_16x16x32_bf16 v[60:63], v[124:127], v[184:187], v[60:63]
  v_mfma_f32_16x16x32_bf16 v[56:59], v[144:147], v[152:155], v[56:59]
  v_mfma_f32_16x16x32_bf16 v[60:63], v[148:151], v[152:155], v[60:63]
  v_mfma_f32_16x16x32_bf16 v[56:59], v[32:35], v[200:203], v[56:59]
  v_mfma_f32_16x16x32_bf16 v[60:63], v[36:39], v[200:203], v[60:63]
  v_mfma_f32_16x16x32_bf16 v[88:91], v[136:139], v[168:171], v[88:91]
  v_mfma_f32_16x16x32_bf16 v[96:99], v[136:139], v[172:175], v[96:99]
  v_mfma_f32_16x16x32_bf16 v[104:107], v[136:139], v[176:179], v[104:107]
  v_mfma_f32_16x16x32_bf16 v[112:115], v[136:139], v[180:183], v[112:115]
  s_nop 2
  v_mul_f32 v56, v20, v56
  v_mul_f32 v57, v20, v57
  v_mul_f32 v58, v20, v58
  v_mul_f32 v59, v20, v59
  v_mul_f32 v60, v20, v60
  v_mul_f32 v61, v20, v61
  v_mul_f32 v62, v20, v62
  v_mul_f32 v63, v20, v63
  v_mul_f32 v24, v56, v56
  v_mul_f32 v25, v57, v57
  v_mul_f32 v26, v58, v58
  v_mul_f32 v27, v59, v59
  v_mul_f32 v28, v60, v60
  v_mul_f32 v29, v61, v61
  v_mul_f32 v30, v62, v62
  v_mul_f32 v31, v63, v63
  v_fma_f32 v24, v24, s68, v236
  v_fma_f32 v25, v25, s68, v236
  v_fma_f32 v26, v26, s68, v236
  v_fma_f32 v27, v27, s68, v236
  v_fma_f32 v28, v28, s68, v236
  v_fma_f32 v29, v29, s68, v236
  v_fma_f32 v30, v30, s68, v236
  v_fma_f32 v31, v31, s68, v236
  v_mul_f32 v24, v24, v56
  v_mul_f32 v25, v25, v57
  v_mul_f32 v26, v26, v58
  v_mul_f32 v27, v27, v59
  v_mul_f32 v28, v28, v60
  v_mul_f32 v29, v29, v61
  v_mul_f32 v30, v30, v62
  v_mul_f32 v31, v31, v63
  v_exp_f32 v24, v24
  v_mfma_f32_16x16x32_bf16 v[64:67], v[120:123], v[188:191], v[64:67]
  v_exp_f32 v25, v25
  v_mfma_f32_16x16x32_bf16 v[68:71], v[124:127], v[188:191], v[68:71]
  v_exp_f32 v26, v26
  v_mfma_f32_16x16x32_bf16 v[64:67], v[144:147], v[156:159], v[64:67]
  v_exp_f32 v27, v27
  v_mfma_f32_16x16x32_bf16 v[68:71], v[148:151], v[156:159], v[68:71]
  v_exp_f32 v28, v28
  v_mfma_f32_16x16x32_bf16 v[64:67], v[32:35], v[204:207], v[64:67]
  v_exp_f32 v29, v29
  v_mfma_f32_16x16x32_bf16 v[68:71], v[36:39], v[204:207], v[68:71]
  v_exp_f32 v30, v30
  v_mfma_f32_16x16x32_bf16 v[92:95], v[140:143], v[168:171], v[92:95]
  v_exp_f32 v31, v31
  v_mfma_f32_16x16x32_bf16 v[100:103], v[140:143], v[172:175], v[100:103]
  v_fma_f32 v24, v24, v16, v16
  v_fma_f32 v25, v25, v16, v16
  v_fma_f32 v26, v26, v16, v16
  v_fma_f32 v27, v27, v16, v16
  v_fma_f32 v28, v28, v16, v16
  v_fma_f32 v29, v29, v16, v16
  v_fma_f32 v30, v30, v16, v16
  v_fma_f32 v31, v31, v16, v16
  v_rcp_f32 v24, v24
  v_mfma_f32_16x16x32_bf16 v[108:111], v[140:143], v[176:179], v[108:111]
  v_rcp_f32 v25, v25
  v_mfma_f32_16x16x32_bf16 v[116:119], v[140:143], v[180:183], v[116:119]
  v_rcp_f32 v26, v26
  v_rcp_f32 v27, v27
  v_rcp_f32 v28, v28
  v_rcp_f32 v29, v29
  v_rcp_f32 v30, v30
  v_rcp_f32 v31, v31
  v_mul_f32 v56, v56, v24
  v_mul_f32 v57, v57, v25
  v_mul_f32 v58, v58, v26
  v_mul_f32 v59, v59, v27
  v_mul_f32 v60, v60, v28
  v_mul_f32 v61, v61, v29
  v_mul_f32 v62, v62, v30
  v_mul_f32 v63, v63, v31
  s_waitcnt lgkmcnt(0)
  s_setprio 2
  v_mul_f32 v64, v21, v64
  v_mul_f32 v65, v21, v65
  v_mul_f32 v66, v21, v66
  v_mul_f32 v67, v21, v67
  v_mul_f32 v68, v21, v68
  v_mul_f32 v69, v21, v69
  v_mul_f32 v70, v21, v70
  v_mul_f32 v71, v21, v71
  v_mul_f32 v24, v64, v64
  v_mul_f32 v25, v65, v65
  v_mul_f32 v26, v66, v66
  v_mul_f32 v27, v67, v67
  v_mul_f32 v28, v68, v68
  v_mul_f32 v29, v69, v69
  v_mul_f32 v30, v70, v70
  v_mul_f32 v31, v71, v71
  v_fma_f32 v24, v24, s68, v236
  v_fma_f32 v25, v25, s68, v236
  v_fma_f32 v26, v26, s68, v236
  v_fma_f32 v27, v27, s68, v236
  v_fma_f32 v28, v28, s68, v236
  v_fma_f32 v29, v29, s68, v236
  v_fma_f32 v30, v30, s68, v236
  v_fma_f32 v31, v31, s68, v236
  v_mul_f32 v24, v24, v64
  v_mul_f32 v25, v25, v65
  v_mul_f32 v26, v26, v66
  v_mul_f32 v27, v27, v67
  v_mul_f32 v28, v28, v68
  v_mul_f32 v29, v29, v69
  v_mul_f32 v30, v30, v70
  v_mul_f32 v31, v31, v71
  v_exp_f32 v24, v24
  v_mfma_f32_16x16x32_bf16 v[72:75], v[120:123], v[192:195], v[72:75]
  v_exp_f32 v25, v25
  v_mfma_f32_16x16x32_bf16 v[76:79], v[124:127], v[192:195], v[76:79]
  v_exp_f32 v26, v26
  v_mfma_f32_16x16x32_bf16 v[72:75], v[144:147], v[160:163], v[72:75]
  v_exp_f32 v27, v27
  v_mfma_f32_16x16x32_bf16 v[76:79], v[148:151], v[160:163], v[76:79]
  v_exp_f32 v28, v28
  v_mfma_f32_16x16x32_bf16 v[72:75], v[32:35], v[208:211], v[72:75]
  v_exp_f32 v29, v29
  v_mfma_f32_16x16x32_bf16 v[76:79], v[36:39], v[208:211], v[76:79]
  v_exp_f32 v30, v30
  v_mfma_f32_16x16x32_bf16 v[88:91], v[48:51], v[184:187], v[88:91]
  v_exp_f32 v31, v31
  v_mfma_f32_16x16x32_bf16 v[96:99], v[48:51], v[188:191], v[96:99]
  v_fma_f32 v24, v24, v17, v17
  v_fma_f32 v25, v25, v17, v17
  v_fma_f32 v26, v26, v17, v17
  v_fma_f32 v27, v27, v17, v17
  v_fma_f32 v28, v28, v17, v17
  v_fma_f32 v29, v29, v17, v17
  v_fma_f32 v30, v30, v17, v17
  v_fma_f32 v31, v31, v17, v17
  v_rcp_f32 v24, v24
  v_mfma_f32_16x16x32_bf16 v[104:107], v[48:51], v[192:195], v[104:107]
  v_rcp_f32 v25, v25
  v_mfma_f32_16x16x32_bf16 v[112:115], v[48:51], v[196:199], v[112:115]
  v_rcp_f32 v26, v26
  v_mfma_f32_16x16x32_bf16 v[92:95], v[52:55], v[184:187], v[92:95]
  v_rcp_f32 v27, v27
  v_mfma_f32_16x16x32_bf16 v[100:103], v[52:55], v[188:191], v[100:103]
  v_rcp_f32 v28, v28
  v_mfma_f32_16x16x32_bf16 v[108:111], v[52:55], v[192:195], v[108:111]
  v_rcp_f32 v29, v29
  v_mfma_f32_16x16x32_bf16 v[116:119], v[52:55], v[196:199], v[116:119]
  v_rcp_f32 v30, v30
  v_rcp_f32 v31, v31
  v_mul_f32 v64, v64, v24
  v_mul_f32 v65, v65, v25
  v_mul_f32 v66, v66, v26
  v_mul_f32 v67, v67, v27
  v_mul_f32 v68, v68, v28
  v_mul_f32 v69, v69, v29
  v_mul_f32 v70, v70, v30
  v_mul_f32 v71, v71, v31
  s_waitcnt vmcnt(0)
  v_xor_b32 v225, s36, v225
  v_bitop3_b32 v225, v225, v227, s36 bitop3:0xf6
  v_bitop3_b32 v225, v225, v229, s36 bitop3:0xf6
  v_bitop3_b32 v225, v225, v231, s36 bitop3:0xf6
  v_cmp_ne_u32 vcc, 0, v225
  s_cbranch_vccnz L_sp_u
L_sp_u_done:
  v_mov_b32 v225, v226
  v_mov_b32 v229, v230
  ds_read_b64_tr_b16 v[48:49], v240 offset:57344
  ds_read_b64_tr_b16 v[50:51], v240 offset:57856
  ds_read_b64_tr_b16 v[52:53], v241 offset:57344
  ds_read_b64_tr_b16 v[54:55], v241 offset:57856
  s_cmp_lg_u32 s3, 4
  s_cbranch_scc1 L_q_nopoll
  s_mov_b32 s37, 20979712
  s_mov_b32 s38, 21000192
  s_mov_b32 s94, 21020672
  buffer_load_dword v244, v12, s[24:27], s37 offen sc1
  buffer_load_dword v245, v12, s[24:27], s38 offen sc1
  buffer_load_dword v246, v12, s[24:27], s94 offen sc1
L_q_nopoll:
  s_setprio 1
  v_mul_f32 v72, v22, v72
  v_mul_f32 v73, v22, v73
  v_mul_f32 v74, v22, v74
  v_mul_f32 v75, v22, v75
  v_mul_f32 v76, v22, v76
  v_mul_f32 v77, v22, v77
  v_mul_f32 v78, v22, v78
  v_mul_f32 v79, v22, v79
  v_mul_f32 v24, v72, v72
  v_mul_f32 v25, v73, v73
  v_mul_f32 v26, v74, v74
  v_mul_f32 v27, v75, v75
  v_mul_f32 v28, v76, v76
  v_mul_f32 v29, v77, v77
  v_mul_f32 v30, v78, v78
  v_mul_f32 v31, v79, v79
  v_fma_f32 v24, v24, s68, v236
  v_fma_f32 v25, v25, s68, v236
  v_fma_f32 v26, v26, s68, v236
  v_fma_f32 v27, v27, s68, v236
  v_fma_f32 v28, v28, s68, v236
  v_fma_f32 v29, v29, s68, v236
  v_fma_f32 v30, v30, s68, v236
  v_fma_f32 v31, v31, s68, v236
  v_mul_f32 v24, v24, v72
  v_mul_f32 v25, v25, v73
  v_mul_f32 v26, v26, v74
  v_mul_f32 v27, v27, v75
  v_mul_f32 v28, v28, v76
  v_mul_f32 v29, v29, v77
  v_mul_f32 v30, v30, v78
  v_mul_f32 v31, v31, v79
  v_exp_f32 v24, v24
  v_mfma_f32_16x16x32_bf16 v[80:83], v[120:123], v[196:199], v[80:83]
  v_exp_f32 v25, v25
  v_mfma_f32_16x16x32_bf16 v[84:87], v[124:127], v[196:199], v[84:87]
  v_exp_f32 v26, v26
  v_mfma_f32_16x16x32_bf16 v[80:83], v[144:147], v[164:167], v[80:83]
  v_exp_f32 v27, v27
  v_mfma_f32_16x16x32_bf16 v[84:87], v[148:151], v[164:167], v[84:87]
  v_exp_f32 v28, v28
  v_mfma_f32_16x16x32_bf16 v[80:83], v[32:35], v[212:215], v[80:83]
  v_exp_f32 v29, v29
  v_mfma_f32_16x16x32_bf16 v[84:87], v[36:39], v[212:215], v[84:87]
  v_exp_f32 v30, v30
  v_mfma_f32_16x16x16_bf16 v[88:91], v[224:225], v[216:217], v[88:91]
  v_exp_f32 v31, v31
  v_mfma_f32_16x16x16_bf16 v[92:95], v[228:229], v[216:217], v[92:95]
  s_setprio 0
  v_fma_f32 v24, v24, v18, v18
  v_fma_f32 v25, v25, v18, v18
  v_fma_f32 v26, v26, v18, v18
  v_fma_f32 v27, v27, v18, v18
  v_fma_f32 v28, v28, v18, v18
  v_fma_f32 v29, v29, v18, v18
  v_fma_f32 v30, v30, v18, v18
  v_fma_f32 v31, v31, v18, v18
  v_rcp_f32 v24, v24
  v_mfma_f32_16x16x16_bf16 v[96:99], v[224:225], v[218:219], v[96:99]
  v_rcp_f32 v25, v25
  v_mfma_f32_16x16x16_bf16 v[100:103], v[228:229], v[218:219], v[100:103]
  v_rcp_f32 v26, v26
  v_mfma_f32_16x16x16_bf16 v[104:107], v[224:225], v[220:221], v[104:107]
  v_rcp_f32 v27, v27
  v_mfma_f32_16x16x16_bf16 v[108:111], v[228:229], v[220:221], v[108:111]
  v_rcp_f32 v28, v28
  v_mfma_f32_16x16x16_bf16 v[112:115], v[224:225], v[222:223], v[112:115]
  v_rcp_f32 v29, v29
  v_mfma_f32_16x16x16_bf16 v[116:119], v[228:229], v[222:223], v[116:119]
  v_rcp_f32 v30, v30
  v_rcp_f32 v31, v31
  v_mul_f32 v72, v72, v24
  v_mul_f32 v73, v73, v25
  v_mul_f32 v74, v74, v26
  v_mul_f32 v75, v75, v27
  v_mul_f32 v76, v76, v28
  v_mul_f32 v77, v77, v29
  v_mul_f32 v78, v78, v30
  v_mul_f32 v79, v79, v31
  s_cmp_lg_u32 s3, 4
  s_cbranch_scc1 L_sp_q_done
  s_waitcnt vmcnt(0)
  v_xor_b32 v244, s36, v244
  v_bitop3_b32 v244, v244, v245, s36 bitop3:0xf6
  v_bitop3_b32 v244, v244, v246, s36 bitop3:0xf6
  v_cmp_ne_u32 vcc, 0, v244
  s_cbranch_vccz L_sp_q_done
  s_mov_b32 s41, 65536
L_sp_q:
  buffer_load_dword v244, v12, s[24:27], s37 offen sc1
  buffer_load_dword v245, v12, s[24:27], s38 offen sc1
  buffer_load_dword v246, v12, s[24:27], s94 offen sc1
  s_waitcnt vmcnt(0)
  v_xor_b32 v244, s36, v244
  v_bitop3_b32 v244, v244, v245, s36 bitop3:0xf6
  v_bitop3_b32 v244, v244, v246, s36 bitop3:0xf6
  v_cmp_ne_u32 vcc, 0, v244
  s_cbranch_vccz L_sp_q_done
  s_sleep 2
  s_sub_u32 s41, s41, 1
  s_cmp_lg_u32 s41, 0
  s_cbranch_scc1 L_sp_q
L_sp_q_done:
  s_barrier
  s_setprio 1
  s_waitcnt lgkmcnt(0)
  s_add_u32 m0, s45, 81920
  s_add_u32 s42, s42, 0
  buffer_load_dwordx4 v10, s[24:27], s42 offen sc1 lds
  v_mul_f32 v80, v23, v80
  v_mfma_f32_16x16x32_bf16 v[88:91], v[40:43], v[152:155], v[88:91]
  v_mul_f32 v81, v23, v81
  v_mul_f32 v82, v23, v82
  v_mul_f32 v83, v23, v83
  v_mul_f32 v84, v23, v84
  v_mul_f32 v85, v23, v85
  v_mfma_f32_16x16x32_bf16 v[96:99], v[40:43], v[156:159], v[96:99]
  v_mul_f32 v86, v23, v86
  s_add_u32 m0, s45, 83520
  s_nop 0
  buffer_load_dwordx4 v10, s[24:27], s42 offen offset:512 sc1 lds
  v_mul_f32 v87, v23, v87
  v_mul_f32 v24, v80, v80
  v_mul_f32 v25, v81, v81
  v_mfma_f32_16x16x32_bf16 v[104:107], v[40:43], v[160:163], v[104:107]
  v_mul_f32 v26, v82, v82
  v_mul_f32 v27, v83, v83
  v_mul_f32 v28, v84, v84
  v_mul_f32 v29, v85, v85
  s_add_u32 m0, s45, 86144
  s_add_u32 s43, s43, 0
  buffer_load_dwordx4 v10, s[24:27], s43 offen sc1 lds
  v_mul_f32 v30, v86, v86
  v_mfma_f32_16x16x32_bf16 v[112:115], v[40:43], v[164:167], v[112:115]
  v_mul_f32 v31, v87, v87
  v_fma_f32 v24, v24, s68, v236
  v_fma_f32 v25, v25, s68, v236
  v_fma_f32 v26, v26, s68, v236
  v_mfma_f32_16x16x32_bf16 v[92:95], v[44:47], v[152:155], v[92:95]
  v_fma_f32 v27, v27, s68, v236
  v_fma_f32 v28, v28, s68, v236
  buffer_load_dwordx2 v[248:249], v11, s[24:27], s50 offen sc1
  v_fma_f32 v29, v29, s68, v236
  v_fma_f32 v30, v30, s68, v236
  v_mfma_f32_16x16x32_bf16 v[100:103], v[44:47], v[156:159], v[100:103]
  v_fma_f32 v31, v31, s68, v236
  v_mul_f32 v24, v24, v80
  v_mul_f32 v25, v25, v81
  v_mul_f32 v26, v26, v82
  v_mul_f32 v27, v27, v83
  v_mfma_f32_16x16x32_bf16 v[108:111], v[44:47], v[160:163], v[108:111]
  buffer_load_dwordx4 v[228:231], v2, s[24:27], s49 offen sc1
  v_mul_f32 v28, v28, v84
  v_mul_f32 v29, v29, v85
  v_mul_f32 v30, v30, v86
  v_mul_f32 v31, v31, v87
  v_mfma_f32_16x16x32_bf16 v[116:119], v[44:47], v[164:167], v[116:119]
  v_exp_f32 v24, v24
  v_exp_f32 v25, v25
  v_exp_f32 v26, v26
  v_mfma_f32_16x16x32_bf16 v[88:91], v[48:51], v[200:203], v[88:91]
  buffer_load_dwordx4 v[232:235], v2, s[24:27], s48 offen sc1
  v_exp_f32 v27, v27
  v_exp_f32 v28, v28
  v_mfma_f32_16x16x32_bf16 v[92:95], v[52:55], v[200:203], v[92:95]
  v_exp_f32 v29, v29
  v_exp_f32 v30, v30
  v_mfma_f32_16x16x32_bf16 v[96:99], v[48:51], v[204:207], v[96:99]
  v_exp_f32 v31, v31
  v_fma_f32 v24, v24, v19, v19
  v_fma_f32 v25, v25, v19, v19
  v_mfma_f32_16x16x32_bf16 v[100:103], v[52:55], v[204:207], v[100:103]
  v_fma_f32 v26, v26, v19, v19
  v_fma_f32 v27, v27, v19, v19
  v_fma_f32 v28, v28, v19, v19
  v_fma_f32 v29, v29, v19, v19
  v_mfma_f32_16x16x32_bf16 v[104:107], v[48:51], v[208:211], v[104:107]
  v_fma_f32 v30, v30, v19, v19
  v_fma_f32 v31, v31, v19, v19
  v_rcp_f32 v24, v24
  v_rcp_f32 v25, v25
  v_mfma_f32_16x16x32_bf16 v[108:111], v[52:55], v[208:211], v[108:111]
  v_rcp_f32 v26, v26
  v_rcp_f32 v27, v27
  v_mfma_f32_16x16x32_bf16 v[112:115], v[48:51], v[212:215], v[112:115]
  v_rcp_f32 v28, v28
  v_rcp_f32 v29, v29
  v_mfma_f32_16x16x32_bf16 v[116:119], v[52:55], v[212:215], v[116:119]
  v_rcp_f32 v30, v30
  v_rcp_f32 v31, v31
  v_mul_f32 v80, v80, v24
  v_mul_f32 v81, v81, v25
  v_mul_f32 v82, v82, v26
  v_mul_f32 v83, v83, v27
  v_mul_f32 v84, v84, v28
  v_mul_f32 v85, v85, v29
  v_mul_f32 v86, v86, v30
  v_mul_f32 v87, v87, v31
  s_setprio 0
L_attn:
  v_and_b32 v13, 0xf0, v2
  v_lshrrev_b32 v16, 4, v1
  v_lshl_add_u32 v13, v16, 9, v13
  s_mul_i32 s37, s40, 20480
  v_add_u32 v11, s37, v2
  v_and_b32 v20, 3, v0
  v_cmp_eq_u32 vcc, 0, v20
  v_mov_b32 v20, 0x3f80
  v_lshlrev_b32 v21, 2, v0
  v_cndmask_b32 v20, 0, v20, vcc
  v_add_u32 v21, 158848, v21
  ds_write_b32 v21, v20
  v_min_u32 v22, 26, v1
  v_min_u32 v23, 36, v1
  v_lshlrev_b32 v22, 2, v22
  v_lshlrev_b32 v23, 2, v23
  s_mov_b32 s32, s22
  s_mov_b32 s33, s23
  s_cmp_lt_u32 s65, 27
  s_cselect_b32 s34, 21516544, 0
  s_add_u32 m0, s45, 107520
  s_add_u32 s42, s42, 491520
  buffer_load_dwordx4 v10, s[24:27], s42 offen sc1 lds
  v_pk_mul_f32 v[88:89], v[88:89], v[56:57]
  v_pk_mul_f32 v[90:91], v[90:91], v[58:59]
  v_pk_mul_f32 v[92:93], v[92:93], v[60:61]
  v_pk_mul_f32 v[94:95], v[94:95], v[62:63]
  v_pk_mul_f32 v[96:97], v[96:97], v[64:65]
  v_pk_mul_f32 v[98:99], v[98:99], v[66:67]
  v_pk_mul_f32 v[100:101], v[100:101], v[68:69]
  v_pk_mul_f32 v[102:103], v[102:103], v[70:71]
  v_pk_mul_f32 v[104:105], v[104:105], v[72:73]
  v_pk_mul_f32 v[106:107], v[106:107], v[74:75]
  v_pk_mul_f32 v[108:109], v[108:109], v[76:77]
  v_pk_mul_f32 v[110:111], v[110:111], v[78:79]
  s_add_u32 m0, s45, 109120
  s_nop 0
  buffer_load_dwordx4 v10, s[24:27], s42 offen offset:512 sc1 lds
  v_pk_mul_f32 v[112:113], v[112:113], v[80:81]
  v_pk_mul_f32 v[114:115], v[114:115], v[82:83]
  v_pk_mul_f32 v[116:117], v[116:117], v[84:85]
  v_pk_mul_f32 v[118:119], v[118:119], v[86:87]
  v_cvt_pk_bf16_f32 v88, v88, v89
  v_cvt_pk_bf16_f32 v89, v90, v91
  v_cvt_pk_bf16_f32 v90, v96, v97
  v_cvt_pk_bf16_f32 v91, v98, v99
  v_cvt_pk_bf16_f32 v92, v92, v93
  v_cvt_pk_bf16_f32 v93, v94, v95
  v_cvt_pk_bf16_f32 v94, v100, v101
  v_cvt_pk_bf16_f32 v95, v102, v103
  s_add_u32 m0, s45, 111744
  s_add_u32 s43, s43, 491520
  buffer_load_dwordx4 v10, s[24:27], s43 offen sc1 lds
  v_cvt_pk_bf16_f32 v104, v104, v105
  v_cvt_pk_bf16_f32 v105, v106, v107
  v_cvt_pk_bf16_f32 v106, v112, v113
  v_cvt_pk_bf16_f32 v107, v114, v115
  v_cvt_pk_bf16_f32 v108, v108, v109
  v_cvt_pk_bf16_f32 v109, v110, v111
  v_cvt_pk_bf16_f32 v110, v116, v117
  v_cvt_pk_bf16_f32 v111, v118, v119
  s_or_b32 s37, s2, s3
  s_cmp_lg_u32 s37, 0
  s_cbranch_scc1 L_noep
  s_mov_b32 s37, 21516288
  s_waitcnt vmcnt(0)
  s_mov_b64 exec, 1
  buffer_store_dword v3, off, s[24:27], s37 offset:0 sc1
  s_mov_b64 exec, -1
L_noep:
  s_waitcnt vmcnt(3) lgkmcnt(0)
  s_barrier
  ds_read_b64 v[250:251], v6 offset:0
  ds_read_b128 v[236:239], v5 offset:0
  ds_read_b64_tr_b16 v[240:241], v7 offset:0
  ds_read_b64_tr_b16 v[242:243], v7 offset:64
  v_permlane16_swap_b32 v88, v90
  v_permlane16_swap_b32 v89, v91
  v_permlane16_swap_b32 v92, v94
  v_permlane16_swap_b32 v93, v95
  v_permlane16_swap_b32 v104, v106
  v_permlane16_swap_b32 v105, v107
  s_waitcnt lgkmcnt(2)
  v_mfma_f32_32x32x4_2b_bf16 v[132:163], v[250:251], v[248:249], 0
  ds_read_b64 v[250:251], v6 offset:512
  v_permlane16_swap_b32 v108, v110
  v_permlane16_swap_b32 v109, v111
  v_mov_b32 v196, 0
  v_mov_b32 v197, 0
  v_mov_b32 v198, 0
  v_mov_b32 v199, 0
  v_mov_b32 v200, 0
  v_mov_b32 v201, 0
  v_mov_b32 v202, 0
  v_mov_b32 v203, 0
  v_mov_b32 v204, 0
  v_mov_b32 v205, 0
  v_mov_b32 v206, 0
  v_mov_b32 v207, 0
  v_mov_b32 v208, 0
  v_mov_b32 v209, 0
  v_mov_b32 v210, 0
  v_mov_b32 v211, 0
  v_mfma_f32_32x32x16_bf16 v[132:147], v[236:239], v[228:231], v[132:147]
  v_mov_b32 v212, 0
  v_mov_b32 v213, 0
  v_mov_b32 v214, 0
  v_mov_b32 v215, 0
  v_mov_b32 v216, 0
  v_mov_b32 v217, 0
  v_mfma_f32_32x32x16_bf16 v[148:163], v[236:239], v[232:235], v[148:163]
  ds_read_b128 v[236:239], v5 offset:512
  v_mov_b32 v218, 0
  v_mov_b32 v219, 0
  v_mov_b32 v220, 0
  v_mov_b32 v221, 0
  v_mov_b32 v222, 0
  v_mov_b32 v223, 0
  v_mov_b32 v224, 0
  v_mov_b32 v225, 0
  v_mov_b32 v226, 0
  v_mov_b32 v227, 0
  s_waitcnt lgkmcnt(0)
  s_setprio 3
  v_exp_f32 v132, v132
  v_exp_f32 v133, v133
  ds_read_b64_tr_b16 v[244:245], v7 offset:256
  ds_read_b64_tr_b16 v[246:247], v7 offset:320
  v_exp_f32 v134, v134
  v_exp_f32 v135, v135
  v_exp_f32 v136, v136
  v_mfma_f32_32x32x4_2b_bf16 v[164:195], v[250:251], v[248:249], 0
  ds_read_b64 v[250:251], v6 offset:1024
  v_exp_f32 v137, v137
  v_exp_f32 v138, v138
  v_exp_f32 v139, v139
  v_exp_f32 v140, v140
  v_exp_f32 v141, v141
  v_exp_f32 v142, v142
  v_exp_f32 v143, v143
  v_exp_f32 v144, v144
  s_add_u32 m0, s45, 0
  s_add_u32 s42, s42, 491520
  buffer_load_dwordx4 v10, s[24:27], s42 offen sc1 lds
  s_waitcnt lgkmcnt(0)
  v_smfmac_f32_32x32x32_bf16 v[196:211], v[240:243], v[132:139], v4
  v_exp_f32 v145, v145
  v_exp_f32 v146, v146
  v_exp_f32 v147, v147
  v_exp_f32 v148, v148
  v_exp_f32 v149, v149
  v_smfmac_f32_32x32x32_bf16 v[196:211], v[244:247], v[140:147], v4
  v_exp_f32 v150, v150
  v_exp_f32 v151, v151
  v_exp_f32 v152, v152
  v_mfma_f32_32x32x16_bf16 v[164:179], v[236:239], v[228:231], v[164:179]
  s_add_u32 m0, s45, 1600
  s_nop 0
  buffer_load_dwordx4 v10, s[24:27], s42 offen offset:512 sc1 lds
  v_exp_f32 v153, v153
  v_exp_f32 v154, v154
  v_exp_f32 v155, v155
  v_exp_f32 v156, v156
  v_exp_f32 v157, v157
  v_smfmac_f32_32x32x32_bf16 v[212:227], v[240:243], v[148:155], v4
  s_add_u32 m0, s45, 4224
  s_add_u32 s43, s43, 491520
  buffer_load_dwordx4 v10, s[24:27], s43 offen sc1 lds
  v_exp_f32 v158, v158
  v_exp_f32 v159, v159
  v_exp_f32 v160, v160
  v_mfma_f32_32x32x16_bf16 v[180:195], v[236:239], v[232:235], v[180:195]
  ds_read_b64_tr_b16 v[240:241], v7 offset:512
  ds_read_b64_tr_b16 v[242:243], v7 offset:576
  ds_read_b128 v[236:239], v5 offset:1024
  v_exp_f32 v161, v161
  v_exp_f32 v162, v162
  v_exp_f32 v163, v163
  v_exp_f32 v164, v164
  v_exp_f32 v165, v165
  v_smfmac_f32_32x32x32_bf16 v[212:227], v[244:247], v[156:163], v4
  s_setprio 1
  ds_read_b64_tr_b16 v[244:245], v7 offset:768
  ds_read_b64_tr_b16 v[246:247], v7 offset:832
  v_exp_f32 v166, v166
  v_exp_f32 v167, v167
  v_exp_f32 v168, v168
  v_mfma_f32_32x32x4_2b_bf16 v[132:163], v[250:251], v[248:249], 0
  ds_read_b64 v[250:251], v6 offset:1536
  v_exp_f32 v169, v169
  v_exp_f32 v170, v170
  v_exp_f32 v171, v171
  v_exp_f32 v172, v172
  v_exp_f32 v173, v173
  v_exp_f32 v174, v174
  v_exp_f32 v175, v175
  v_exp_f32 v176, v176
  buffer_store_dwordx4 v[88:91], v2, s[32:35], s62 offen offset:0 sc1
  s_waitcnt lgkmcnt(0)
  v_smfmac_f32_32x32x32_bf16 v[196:211], v[240:243], v[164:171], v4
  v_exp_f32 v177, v177
  v_exp_f32 v178, v178
  v_exp_f32 v179, v179
  v_exp_f32 v180, v180
  v_exp_f32 v181, v181
  v_smfmac_f32_32x32x32_bf16 v[196:211], v[244:247], v[172:179], v4
  v_exp_f32 v182, v182
  v_exp_f32 v183, v183
  v_exp_f32 v184, v184
  v_mfma_f32_32x32x16_bf16 v[132:147], v[236:239], v[228:231], v[132:147]
  s_setprio 0
  v_exp_f32 v185, v185
  v_exp_f32 v186, v186
  v_exp_f32 v187, v187
  v_exp_f32 v188, v188
  v_exp_f32 v189, v189
  v_smfmac_f32_32x32x32_bf16 v[212:227], v[240:243], v[180:187], v4
  v_exp_f32 v190, v190
  v_exp_f32 v191, v191
  v_exp_f32 v192, v192
  v_mfma_f32_32x32x16_bf16 v[148:163], v[236:239], v[232:235], v[148:163]
  ds_read_b64_tr_b16 v[240:241], v7 offset:1024
  ds_read_b64_tr_b16 v[242:243], v7 offset:1088
  ds_read_b128 v[236:239], v5 offset:1536
  v_exp_f32 v193, v193
  v_exp_f32 v194, v194
  v_exp_f32 v195, v195
  v_exp_f32 v132, v132
  v_exp_f32 v133, v133
  v_smfmac_f32_32x32x32_bf16 v[212:227], v[244:247], v[188:195], v4
  ds_read_b64_tr_b16 v[244:245], v7 offset:1280
  ds_read_b64_tr_b16 v[246:247], v7 offset:1344
  v_exp_f32 v134, v134
  v_exp_f32 v135, v135
  v_exp_f32 v136, v136
  v_mfma_f32_32x32x4_2b_bf16 v[164:195], v[250:251], v[248:249], 0
  s_waitcnt vmcnt(1)
  s_barrier
  s_setprio 3
  ds_read_b64 v[250:251], v6 offset:25600
  v_exp_f32 v137, v137
  v_exp_f32 v138, v138
  v_exp_f32 v139, v139
  v_exp_f32 v140, v140
  v_exp_f32 v141, v141
  v_exp_f32 v142, v142
  v_exp_f32 v143, v143
  v_exp_f32 v144, v144
  buffer_store_dwordx4 v[92:95], v2, s[32:35], s62 offen offset:1024 sc1
  s_waitcnt lgkmcnt(0)
  v_smfmac_f32_32x32x32_bf16 v[196:211], v[240:243], v[132:139], v4
  v_exp_f32 v145, v145
  v_exp_f32 v146, v146
  v_exp_f32 v147, v147
  v_exp_f32 v148, v148
  v_exp_f32 v149, v149
  v_smfmac_f32_32x32x32_bf16 v[196:211], v[244:247], v[140:147], v4
  v_exp_f32 v150, v150
  v_exp_f32 v151, v151
  v_exp_f32 v152, v152
  v_mfma_f32_32x32x16_bf16 v[164:179], v[236:239], v[228:231], v[164:179]
  v_exp_f32 v153, v153
  v_exp_f32 v154, v154
  v_exp_f32 v155, v155
  v_exp_f32 v156, v156
  v_exp_f32 v157, v157
  v_smfmac_f32_32x32x32_bf16 v[212:227], v[240:243], v[148:155], v4
  v_exp_f32 v158, v158
  v_exp_f32 v159, v159
  v_exp_f32 v160, v160
  v_mfma_f32_32x32x16_bf16 v[180:195], v[236:239], v[232:235], v[180:195]
  ds_read_b64_tr_b16 v[240:241], v7 offset:1536
  ds_read_b64_tr_b16 v[242:243], v7 offset:1600
  ds_read_b128 v[236:239], v5 offset:25600
  v_exp_f32 v161, v161
  v_exp_f32 v162, v162
  v_exp_f32 v163, v163
  v_exp_f32 v164, v164
  v_exp_f32 v165, v165
  v_smfmac_f32_32x32x32_bf16 v[212:227], v[244:247], v[156:163], v4
  ds_read_b64_tr_b16 v[244:245], v7 offset:1792
  ds_read_b64_tr_b16 v[246:247], v7 offset:1856
  v_exp_f32 v166, v166
  v_exp_f32 v167, v167
  v_exp_f32 v168, v168
  v_mfma_f32_32x32x4_2b_bf16 v[132:163], v[250:251], v[248:249], 0
  ds_read_b64 v[250:251], v6 offset:26112
  s_setprio 2
  v_exp_f32 v169, v169
  v_exp_f32 v170, v170
  v_exp_f32 v171, v171
  v_exp_f32 v172, v172
  v_exp_f32 v173, v173
  v_exp_f32 v174, v174
  v_exp_f32 v175, v175
  v_exp_f32 v176, v176
  buffer_store_dwordx4 v[104:107], v2, s[32:35], s78 offen offset:0 sc1
  s_waitcnt lgkmcnt(0)
  v_smfmac_f32_32x32x32_bf16 v[196:211], v[240:243], v[164:171], v4
  v_exp_f32 v177, v177
  v_exp_f32 v178, v178
  v_exp_f32 v179, v179
  v_exp_f32 v180, v180
  v_exp_f32 v181, v181
  v_smfmac_f32_32x32x32_bf16 v[196:211], v[244:247], v[172:179], v4
  v_exp_f32 v182, v182
  v_exp_f32 v183, v183
  v_exp_f32 v184, v184
  v_mfma_f32_32x32x16_bf16 v[132:147], v[236:239], v[228:231], v[132:147]
  v_exp_f32 v185, v185
  v_exp_f32 v186, v186
  v_exp_f32 v187, v187
  v_exp_f32 v188, v188
  v_exp_f32 v189, v189
  v_smfmac_f32_32x32x32_bf16 v[212:227], v[240:243], v[180:187], v4
  v_exp_f32 v190, v190
  v_exp_f32 v191, v191
  v_exp_f32 v192, v192
  v_mfma_f32_32x32x16_bf16 v[148:163], v[236:239], v[232:235], v[148:163]
  s_mov_b32 s93, 25600
  v_mad_i32_i24 v7, v8, s93, v7
  ds_read_b64_tr_b16 v[240:241], v7 offset:0
  ds_read_b64_tr_b16 v[242:243], v7 offset:64
  ds_read_b128 v[236:239], v5 offset:26112
  v_exp_f32 v193, v193
  v_exp_f32 v194, v194
  v_exp_f32 v195, v195
  v_exp_f32 v132, v132
  v_exp_f32 v133, v133
  v_smfmac_f32_32x32x32_bf16 v[212:227], v[244:247], v[188:195], v4
  ds_read_b64_tr_b16 v[244:245], v7 offset:256
  ds_read_b64_tr_b16 v[246:247], v7 offset:320
  v_exp_f32 v134, v134
  v_exp_f32 v135, v135
  v_exp_f32 v136, v136
  v_mfma_f32_32x32x4_2b_bf16 v[164:195], v[250:251], v[248:249], 0
  ds_read_b64 v[250:251], v6 offset:26624
  v_exp_f32 v137, v137
  v_exp_f32 v138, v138
  v_exp_f32 v139, v139
  v_exp_f32 v140, v140
  v_exp_f32 v141, v141
  v_exp_f32 v142, v142
  v_exp_f32 v143, v143
  v_exp_f32 v144, v144
  buffer_store_dwordx4 v[108:111], v2, s[32:35], s78 offen offset:1024 sc1
  s_waitcnt lgkmcnt(0)
  v_smfmac_f32_32x32x32_bf16 v[196:211], v[240:243], v[132:139], v4
  v_exp_f32 v145, v145
  v_exp_f32 v146, v146
  v_exp_f32 v147, v147
  v_exp_f32 v148, v148
  v_exp_f32 v149, v149
  v_smfmac_f32_32x32x32_bf16 v[196:211], v[244:247], v[140:147], v4
  v_exp_f32 v150, v150
  v_exp_f32 v151, v151
  v_exp_f32 v152, v152
  v_mfma_f32_32x32x16_bf16 v[164:179], v[236:239], v[228:231], v[164:179]
  v_exp_f32 v153, v153
  v_exp_f32 v154, v154
  v_exp_f32 v155, v155
  v_exp_f32 v156, v156
  v_exp_f32 v157, v157
  v_smfmac_f32_32x32x32_bf16 v[212:227], v[240:243], v[148:155], v4
  v_exp_f32 v158, v158
  v_exp_f32 v159, v159
  v_exp_f32 v160, v160
  v_mfma_f32_32x32x16_bf16 v[180:195], v[236:239], v[232:235], v[180:195]
  ds_read_b64_tr_b16 v[240:241], v7 offset:512
  ds_read_b64_tr_b16 v[242:243], v7 offset:576
  ds_read_b128 v[236:239], v5 offset:26624
  v_exp_f32 v161, v161
  v_exp_f32 v162, v162
  v_exp_f32 v163, v163
  v_exp_f32 v164, v164
  v_exp_f32 v165, v165
  v_smfmac_f32_32x32x32_bf16 v[212:227], v[244:247], v[156:163], v4
  s_setprio 1
  ds_read_b64_tr_b16 v[244:245], v7 offset:768
  ds_read_b64_tr_b16 v[246:247], v7 offset:832
  v_exp_f32 v166, v166
  v_exp_f32 v167, v167
  v_exp_f32 v168, v168
  v_mfma_f32_32x32x4_2b_bf16 v[132:163], v[250:251], v[248:249], 0
  ds_read_b64 v[250:251], v6 offset:27136
  v_exp_f32 v169, v169
  v_exp_f32 v170, v170
  v_exp_f32 v171, v171
  v_exp_f32 v172, v172
  v_exp_f32 v173, v173
  v_exp_f32 v174, v174
  v_exp_f32 v175, v175
  v_exp_f32 v176, v176
  s_add_u32 m0, s45, 25600
  s_add_u32 s42, s42, 491520
  buffer_load_dwordx4 v10, s[24:27], s42 offen sc1 lds
  s_waitcnt lgkmcnt(0)
  v_smfmac_f32_32x32x32_bf16 v[196:211], v[240:243], v[164:171], v4
  v_exp_f32 v177, v177
  v_exp_f32 v178, v178
  v_exp_f32 v179, v179
  v_exp_f32 v180, v180
  v_exp_f32 v181, v181
  v_smfmac_f32_32x32x32_bf16 v[196:211], v[244:247], v[172:179], v4
  v_exp_f32 v182, v182
  v_exp_f32 v183, v183
  v_exp_f32 v184, v184
  v_mfma_f32_32x32x16_bf16 v[132:147], v[236:239], v[228:231], v[132:147]
  s_setprio 0
  s_add_u32 m0, s45, 27200
  s_nop 0
  buffer_load_dwordx4 v10, s[24:27], s42 offen offset:512 sc1 lds
  v_exp_f32 v185, v185
  v_exp_f32 v186, v186
  v_exp_f32 v187, v187
  v_exp_f32 v188, v188
  v_exp_f32 v189, v189
  v_smfmac_f32_32x32x32_bf16 v[212:227], v[240:243], v[180:187], v4
  s_add_u32 m0, s45, 29824
  s_add_u32 s43, s43, 491520
  buffer_load_dwordx4 v10, s[24:27], s43 offen sc1 lds
  v_exp_f32 v190, v190
  v_exp_f32 v191, v191
  v_exp_f32 v192, v192
  v_mfma_f32_32x32x16_bf16 v[148:163], v[236:239], v[232:235], v[148:163]
  ds_read_b64_tr_b16 v[240:241], v7 offset:1024
  ds_read_b64_tr_b16 v[242:243], v7 offset:1088
  ds_read_b128 v[236:239], v5 offset:27136
  v_exp_f32 v193, v193
  v_exp_f32 v194, v194
  v_exp_f32 v195, v195
  v_exp_f32 v132, v132
  v_exp_f32 v133, v133
  v_smfmac_f32_32x32x32_bf16 v[212:227], v[244:247], v[188:195], v4
  ds_read_b64_tr_b16 v[244:245], v7 offset:1280
  ds_read_b64_tr_b16 v[246:247], v7 offset:1344
  v_exp_f32 v134, v134
  v_exp_f32 v135, v135
  v_exp_f32 v136, v136
  v_mfma_f32_32x32x4_2b_bf16 v[164:195], v[250:251], v[248:249], 0
  s_setprio 3
  v_add_u32 v6, 4294885376, v6
  ds_read_b64 v[250:251], v6 offset:0
  v_exp_f32 v137, v137
  v_exp_f32 v138, v138
  v_exp_f32 v139, v139
  v_exp_f32 v140, v140
  v_exp_f32 v141, v141
  v_exp_f32 v142, v142
  v_exp_f32 v143, v143
  v_exp_f32 v144, v144
  s_add_u32 m0, s45, 51200
  s_add_u32 s42, s42, 491520
  buffer_load_dwordx4 v10, s[24:27], s42 offen sc1 lds
  s_waitcnt lgkmcnt(0)
  v_smfmac_f32_32x32x32_bf16 v[196:211], v[240:243], v[132:139], v4
  v_exp_f32 v145, v145
  v_exp_f32 v146, v146
  v_exp_f32 v147, v147
  v_exp_f32 v148, v148
  v_exp_f32 v149, v149
  v_smfmac_f32_32x32x32_bf16 v[196:211], v[244:247], v[140:147], v4
  v_exp_f32 v150, v150
  v_exp_f32 v151, v151
  v_exp_f32 v152, v152
  v_mfma_f32_32x32x16_bf16 v[164:179], v[236:239], v[228:231], v[164:179]
  s_add_u32 m0, s45, 52800
  s_nop 0
  buffer_load_dwordx4 v10, s[24:27], s42 offen offset:512 sc1 lds
  v_exp_f32 v153, v153
  v_exp_f32 v154, v154
  v_exp_f32 v155, v155
  v_exp_f32 v156, v156
  v_exp_f32 v157, v157
  v_smfmac_f32_32x32x32_bf16 v[212:227], v[240:243], v[148:155], v4
  s_add_u32 m0, s45, 55424
  s_add_u32 s43, s43, 491520
  buffer_load_dwordx4 v10, s[24:27], s43 offen sc1 lds
  v_exp_f32 v158, v158
  v_exp_f32 v159, v159
  v_exp_f32 v160, v160
  v_mfma_f32_32x32x16_bf16 v[180:195], v[236:239], v[232:235], v[180:195]
  ds_read_b64_tr_b16 v[240:241], v7 offset:1536
  ds_read_b64_tr_b16 v[242:243], v7 offset:1600
  v_add_u32 v5, 4294885376, v5
  ds_read_b128 v[236:239], v5 offset:0
  v_exp_f32 v161, v161
  v_exp_f32 v162, v162
  v_exp_f32 v163, v163
  v_exp_f32 v164, v164
  v_exp_f32 v165, v165
  v_smfmac_f32_32x32x32_bf16 v[212:227], v[244:247], v[156:163], v4
  ds_read_b64_tr_b16 v[244:245], v7 offset:1792
  ds_read_b64_tr_b16 v[246:247], v7 offset:1856
  v_exp_f32 v166, v166
  v_exp_f32 v167, v167
  v_exp_f32 v168, v168
  v_mfma_f32_32x32x4_2b_bf16 v[132:163], v[250:251], v[248:249], 0
  s_waitcnt vmcnt(6)
  s_mov_b64 exec, 1
  buffer_store_dword v3, off, s[24:27], s61 offset:0 sc1
  s_mov_b64 exec, -1
  ds_read_b64 v[250:251], v6 offset:512
  s_setprio 2
  v_exp_f32 v169, v169
  v_exp_f32 v170, v170
  v_exp_f32 v171, v171
  v_exp_f32 v172, v172
  v_exp_f32 v173, v173
  v_exp_f32 v174, v174
  v_exp_f32 v175, v175
  v_exp_f32 v176, v176
  s_add_u32 m0, s45, 133120
  s_add_u32 s42, s42, 491520
  buffer_load_dwordx4 v10, s[24:27], s42 offen sc1 lds
  s_waitcnt lgkmcnt(0)
  v_smfmac_f32_32x32x32_bf16 v[196:211], v[240:243], v[164:171], v4
  v_exp_f32 v177, v177
  v_exp_f32 v178, v178
  v_exp_f32 v179, v179
  v_exp_f32 v180, v180
  v_exp_f32 v181, v181
  v_smfmac_f32_32x32x32_bf16 v[196:211], v[244:247], v[172:179], v4
  v_exp_f32 v182, v182
  v_exp_f32 v183, v183
  v_exp_f32 v184, v184
  v_mfma_f32_32x32x16_bf16 v[132:147], v[236:239], v[228:231], v[132:147]
  s_add_u32 m0, s45, 134720
  s_nop 0
  buffer_load_dwordx4 v10, s[24:27], s42 offen offset:512 sc1 lds
  v_exp_f32 v185, v185
  v_exp_f32 v186, v186
  v_exp_f32 v187, v187
  v_exp_f32 v188, v188
  v_exp_f32 v189, v189
  v_smfmac_f32_32x32x32_bf16 v[212:227], v[240:243], v[180:187], v4
  s_add_u32 m0, s45, 137344
  s_add_u32 s43, s43, 491520
  buffer_load_dwordx4 v10, s[24:27], s43 offen sc1 lds
  v_exp_f32 v190, v190
  v_exp_f32 v191, v191
  v_exp_f32 v192, v192
  v_mfma_f32_32x32x16_bf16 v[148:163], v[236:239], v[232:235], v[148:163]
  s_mov_b32 s93, 4294859776
  v_mad_i32_i24 v7, v8, s93, v7
  ds_read_b64_tr_b16 v[240:241], v7 offset:0
  ds_read_b64_tr_b16 v[242:243], v7 offset:64
  ds_read_b128 v[236:239], v5 offset:512
  v_exp_f32 v193, v193
  v_exp_f32 v194, v194
  v_exp_f32 v195, v195
  v_exp_f32 v132, v132
  v_exp_f32 v133, v133
  v_smfmac_f32_32x32x32_bf16 v[212:227], v[244:247], v[188:195], v4
  ds_read_b64_tr_b16 v[244:245], v7 offset:256
  ds_read_b64_tr_b16 v[246:247], v7 offset:320
  v_exp_f32 v134, v134
  v_exp_f32 v135, v135
  v_exp_f32 v136, v136
  v_mfma_f32_32x32x4_2b_bf16 v[164:195], v[250:251], v[248:249], 0
  ds_read_b64 v[250:251], v6 offset:1024
  v_exp_f32 v137, v137
  v_exp_f32 v138, v138
  v_exp_f32 v139, v139
  v_exp_f32 v140, v140
  v_exp_f32 v141, v141
  v_exp_f32 v142, v142
  v_exp_f32 v143, v143
  v_exp_f32 v144, v144
  s_mov_b64 s[32:33], s[4:5]
  s_mov_b32 s34, 2621440
  buffer_load_dwordx2 v[20:21], v253, s[32:35], s57 offen
  s_waitcnt lgkmcnt(0)
  v_smfmac_f32_32x32x32_bf16 v[196:211], v[240:243], v[132:139], v4
  v_exp_f32 v145, v145
  v_exp_f32 v146, v146
  v_exp_f32 v147, v147
  v_exp_f32 v148, v148
  v_exp_f32 v149, v149
  v_smfmac_f32_32x32x32_bf16 v[196:211], v[244:247], v[140:147], v4
  v_exp_f32 v150, v150
  v_exp_f32 v151, v151
  v_exp_f32 v152, v152
  v_mfma_f32_32x32x16_bf16 v[164:179], v[236:239], v[228:231], v[164:179]
  buffer_load_dword v15, v255, s[32:35], s57 offen
  v_exp_f32 v153, v153
  v_exp_f32 v154, v154
  v_exp_f32 v155, v155
  v_exp_f32 v156, v156
  v_exp_f32 v157, v157
  v_smfmac_f32_32x32x32_bf16 v[212:227], v[240:243], v[148:155], v4
  s_mov_b64 exec, 1
  buffer_load_dword v9, off, s[24:27], s53 sc1
  s_mov_b64 exec, -1
  v_exp_f32 v158, v158
  v_exp_f32 v159, v159
  v_exp_f32 v160, v160
  v_mfma_f32_32x32x16_bf16 v[180:195], v[236:239], v[232:235], v[180:195]
  ds_read_b64_tr_b16 v[240:241], v7 offset:512
  ds_read_b64_tr_b16 v[242:243], v7 offset:576
  ds_read_b128 v[236:239], v5 offset:1024
  v_exp_f32 v161, v161
  v_exp_f32 v162, v162
  v_exp_f32 v163, v163
  v_exp_f32 v164, v164
  v_exp_f32 v165, v165
  v_smfmac_f32_32x32x32_bf16 v[212:227], v[244:247], v[156:163], v4
  s_setprio 1
  ds_read_b64_tr_b16 v[244:245], v7 offset:768
  ds_read_b64_tr_b16 v[246:247], v7 offset:832
  v_exp_f32 v166, v166
  v_exp_f32 v167, v167
  v_exp_f32 v168, v168
  v_mfma_f32_32x32x4_2b_bf16 v[132:163], v[250:251], v[248:249], 0
  ds_read_b64 v[250:251], v6 offset:1536
  v_exp_f32 v169, v169
  v_exp_f32 v170, v170
  v_exp_f32 v171, v171
  v_exp_f32 v172, v172
  v_exp_f32 v173, v173
  v_exp_f32 v174, v174
  v_exp_f32 v175, v175
  v_exp_f32 v176, v176
  s_mov_b32 exec_hi, 0
  buffer_load_dword v9, v2, s[24:27], s52 offen sc1
  s_mov_b64 exec, -1
  s_waitcnt lgkmcnt(0)
  v_smfmac_f32_32x32x32_bf16 v[196:211], v[240:243], v[164:171], v4
  v_exp_f32 v177, v177
  v_exp_f32 v178, v178
  v_exp_f32 v179, v179
  v_exp_f32 v180, v180
  v_exp_f32 v181, v181
  v_smfmac_f32_32x32x32_bf16 v[196:211], v[244:247], v[172:179], v4
  v_exp_f32 v182, v182
  v_exp_f32 v183, v183
  v_exp_f32 v184, v184
  v_mfma_f32_32x32x16_bf16 v[132:147], v[236:239], v[228:231], v[132:147]
  s_setprio 0
  v_exp_f32 v185, v185
  v_exp_f32 v186, v186
  v_exp_f32 v187, v187
  v_exp_f32 v188, v188
  v_exp_f32 v189, v189
  v_smfmac_f32_32x32x32_bf16 v[212:227], v[240:243], v[180:187], v4
  v_exp_f32 v190, v190
  v_exp_f32 v191, v191
  v_exp_f32 v192, v192
  v_mfma_f32_32x32x16_bf16 v[148:163], v[236:239], v[232:235], v[148:163]
  ds_read_b64_tr_b16 v[240:241], v7 offset:1024
  ds_read_b64_tr_b16 v[242:243], v7 offset:1088
  ds_read_b128 v[236:239], v5 offset:1536
  v_exp_f32 v193, v193
  v_exp_f32 v194, v194
  v_exp_f32 v195, v195
  v_exp_f32 v132, v132
  v_exp_f32 v133, v133
  v_smfmac_f32_32x32x32_bf16 v[212:227], v[244:247], v[188:195], v4
  ds_read_b64_tr_b16 v[244:245], v7 offset:1280
  ds_read_b64_tr_b16 v[246:247], v7 offset:1344
  v_exp_f32 v134, v134
  v_exp_f32 v135, v135
  v_exp_f32 v136, v136
  v_mfma_f32_32x32x4_2b_bf16 v[164:195], v[250:251], v[248:249], 0
  s_waitcnt vmcnt(4)
  s_barrier
  s_setprio 3
  ds_read_b64 v[250:251], v6 offset:25600
  v_exp_f32 v137, v137
  v_exp_f32 v138, v138
  v_exp_f32 v139, v139
  v_exp_f32 v140, v140
  v_exp_f32 v141, v141
  v_exp_f32 v142, v142
  v_exp_f32 v143, v143
  v_exp_f32 v144, v144
  buffer_load_dword v16, v22, s[24:27], s58 offen sc1
  s_waitcnt lgkmcnt(0)
  v_smfmac_f32_32x32x32_bf16 v[196:211], v[240:243], v[132:139], v4
  v_exp_f32 v145, v145
  v_exp_f32 v146, v146
  v_exp_f32 v147, v147
  v_exp_f32 v148, v148
  v_exp_f32 v149, v149
  v_smfmac_f32_32x32x32_bf16 v[196:211], v[244:247], v[140:147], v4
  v_exp_f32 v150, v150
  v_exp_f32 v151, v151
  v_exp_f32 v152, v152
  v_mfma_f32_32x32x16_bf16 v[164:179], v[236:239], v[228:231], v[164:179]
  buffer_load_dword v17, v23, s[24:27], s59 offen sc1
  v_exp_f32 v153, v153
  v_exp_f32 v154, v154
  v_exp_f32 v155, v155
  v_exp_f32 v156, v156
  v_exp_f32 v157, v157
  v_smfmac_f32_32x32x32_bf16 v[212:227], v[240:243], v[148:155], v4
  s_add_u32 m0, s45, 81920
  s_add_u32 s42, s42, 491520
  buffer_load_dwordx4 v10, s[24:27], s42 offen sc1 lds
  v_exp_f32 v158, v158
  v_exp_f32 v159, v159
  v_exp_f32 v160, v160
  v_mfma_f32_32x32x16_bf16 v[180:195], v[236:239], v[232:235], v[180:195]
  ds_read_b64_tr_b16 v[240:241], v7 offset:1536
  ds_read_b64_tr_b16 v[242:243], v7 offset:1600
  ds_read_b128 v[236:239], v5 offset:25600
  v_exp_f32 v161, v161
  v_exp_f32 v162, v162
  v_exp_f32 v163, v163
  v_exp_f32 v164, v164
  v_exp_f32 v165, v165
  v_smfmac_f32_32x32x32_bf16 v[212:227], v[244:247], v[156:163], v4
  ds_read_b64_tr_b16 v[244:245], v7 offset:1792
  ds_read_b64_tr_b16 v[246:247], v7 offset:1856
  v_exp_f32 v166, v166
  v_exp_f32 v167, v167
  v_exp_f32 v168, v168
  v_mfma_f32_32x32x4_2b_bf16 v[132:163], v[250:251], v[248:249], 0
  ds_read_b64 v[250:251], v6 offset:26112
  v_exp_f32 v169, v169
  v_exp_f32 v170, v170
  v_exp_f32 v171, v171
  v_exp_f32 v172, v172
  v_exp_f32 v173, v173
  v_exp_f32 v174, v174
  v_exp_f32 v175, v175
  v_exp_f32 v176, v176
  s_add_u32 m0, s45, 83520
  s_nop 0
  buffer_load_dwordx4 v10, s[24:27], s42 offen offset:512 sc1 lds
  s_waitcnt lgkmcnt(0)
  v_smfmac_f32_32x32x32_bf16 v[196:211], v[240:243], v[164:171], v4
  v_exp_f32 v177, v177
  v_exp_f32 v178, v178
  v_exp_f32 v179, v179
  v_exp_f32 v180, v180
  v_exp_f32 v181, v181
  v_smfmac_f32_32x32x32_bf16 v[196:211], v[244:247], v[172:179], v4
  v_exp_f32 v182, v182
  v_exp_f32 v183, v183
  v_exp_f32 v184, v184
  v_mfma_f32_32x32x16_bf16 v[132:147], v[236:239], v[228:231], v[132:147]
  s_add_u32 m0, s45, 86144
  s_add_u32 s43, s43, 491520
  buffer_load_dwordx4 v10, s[24:27], s43 offen sc1 lds
  v_exp_f32 v185, v185
  v_exp_f32 v186, v186
  v_exp_f32 v187, v187
  v_exp_f32 v188, v188
  v_exp_f32 v189, v189
  v_smfmac_f32_32x32x32_bf16 v[212:227], v[240:243], v[180:187], v4
  s_add_u32 m0, s45, 107520
  s_add_u32 s42, s42, 491520
  buffer_load_dwordx4 v10, s[24:27], s42 offen sc1 lds
  v_exp_f32 v190, v190
  v_exp_f32 v191, v191
  v_exp_f32 v192, v192
  v_mfma_f32_32x32x16_bf16 v[148:163], v[236:239], v[232:235], v[148:163]
  s_mov_b32 s93, 25600
  v_mad_i32_i24 v7, v8, s93, v7
  ds_read_b64_tr_b16 v[240:241], v7 offset:0
  ds_read_b64_tr_b16 v[242:243], v7 offset:64
  ds_read_b128 v[236:239], v5 offset:26112
  v_exp_f32 v193, v193
  v_exp_f32 v194, v194
  v_exp_f32 v195, v195
  v_exp_f32 v132, v132
  v_exp_f32 v133, v133
  v_smfmac_f32_32x32x32_bf16 v[212:227], v[244:247], v[188:195], v4
  ds_read_b64_tr_b16 v[244:245], v7 offset:256
  ds_read_b64_tr_b16 v[246:247], v7 offset:320
  v_exp_f32 v134, v134
  v_exp_f32 v135, v135
  v_exp_f32 v136, v136
  v_mfma_f32_32x32x4_2b_bf16 v[164:195], v[250:251], v[248:249], 0
  s_waitcnt vmcnt(4)
  v_xor_b32 v16, s36, v16
  v_bitop3_b32 v16, v16, v17, s36 bitop3:0xf6
  v_cmp_ne_u32 vcc, 0, v16
  s_cbranch_vccnz L_sp_h
L_sp_h_done:
  ds_read_b64 v[250:251], v6 offset:26624
  s_setprio 2
  v_exp_f32 v137, v137
  v_exp_f32 v138, v138
  v_exp_f32 v139, v139
  v_exp_f32 v140, v140
  v_exp_f32 v141, v141
  v_exp_f32 v142, v142
  v_exp_f32 v143, v143
  v_exp_f32 v144, v144
  s_add_u32 m0, s45, 109120
  s_nop 0
  buffer_load_dwordx4 v10, s[24:27], s42 offen offset:512 sc1 lds
  s_waitcnt lgkmcnt(0)
  v_smfmac_f32_32x32x32_bf16 v[196:211], v[240:243], v[132:139], v4
  v_exp_f32 v145, v145
  v_exp_f32 v146, v146
  v_exp_f32 v147, v147
  v_exp_f32 v148, v148
  v_exp_f32 v149, v149
  v_smfmac_f32_32x32x32_bf16 v[196:211], v[244:247], v[140:147], v4
  v_exp_f32 v150, v150
  v_exp_f32 v151, v151
  v_exp_f32 v152, v152
  v_mfma_f32_32x32x16_bf16 v[164:179], v[236:239], v[228:231], v[164:179]
  s_add_u32 m0, s45, 111744
  s_add_u32 s43, s43, 491520
  buffer_load_dwordx4 v10, s[24:27], s43 offen sc1 lds
  v_exp_f32 v153, v153
  v_exp_f32 v154, v154
  v_exp_f32 v155, v155
  v_exp_f32 v156, v156
  v_exp_f32 v157, v157
  v_smfmac_f32_32x32x32_bf16 v[212:227], v[240:243], v[148:155], v4
  buffer_load_dwordx4 v[24:27], v13, s[24:27], s54 offen offset:0 sc1
  v_exp_f32 v158, v158
  v_exp_f32 v159, v159
  v_exp_f32 v160, v160
  v_mfma_f32_32x32x16_bf16 v[180:195], v[236:239], v[232:235], v[180:195]
  ds_read_b64_tr_b16 v[240:241], v7 offset:512
  ds_read_b64_tr_b16 v[242:243], v7 offset:576
  ds_read_b128 v[236:239], v5 offset:26624
  v_exp_f32 v161, v161
  v_exp_f32 v162, v162
  v_exp_f32 v163, v163
  v_exp_f32 v164, v164
  v_exp_f32 v165, v165
  v_smfmac_f32_32x32x32_bf16 v[212:227], v[244:247], v[156:163], v4
  ds_read_b64_tr_b16 v[244:245], v7 offset:768
  ds_read_b64_tr_b16 v[246:247], v7 offset:832
  v_exp_f32 v166, v166
  v_exp_f32 v167, v167
  v_exp_f32 v168, v168
  v_mfma_f32_32x32x4_2b_bf16 v[132:163], v[250:251], v[248:249], 0
  ds_read_b64 v[250:251], v6 offset:27136
  v_exp_f32 v169, v169
  v_exp_f32 v170, v170
  v_exp_f32 v171, v171
  v_exp_f32 v172, v172
  v_exp_f32 v173, v173
  v_exp_f32 v174, v174
  v_exp_f32 v175, v175
  v_exp_f32 v176, v176
  buffer_load_dwordx4 v[28:31], v13, s[24:27], s54 offen offset:2048 sc1
  s_waitcnt lgkmcnt(0)
  v_smfmac_f32_32x32x32_bf16 v[196:211], v[240:243], v[164:171], v4
  v_exp_f32 v177, v177
  v_exp_f32 v178, v178
  v_exp_f32 v179, v179
  v_exp_f32 v180, v180
  v_exp_f32 v181, v181
  v_smfmac_f32_32x32x32_bf16 v[196:211], v[244:247], v[172:179], v4
  v_exp_f32 v182, v182
  v_exp_f32 v183, v183
  v_exp_f32 v184, v184
  v_mfma_f32_32x32x16_bf16 v[132:147], v[236:239], v[228:231], v[132:147]
  s_add_u32 s54, s54, 4096
  buffer_load_dwordx4 v[32:35], v13, s[24:27], s54 offen offset:0 sc1
  v_exp_f32 v185, v185
  v_exp_f32 v186, v186
  v_exp_f32 v187, v187
  v_exp_f32 v188, v188
  v_exp_f32 v189, v189
  v_smfmac_f32_32x32x32_bf16 v[212:227], v[240:243], v[180:187], v4
  buffer_load_dwordx4 v[36:39], v13, s[24:27], s54 offen offset:2048 sc1
  v_exp_f32 v190, v190
  v_exp_f32 v191, v191
  v_exp_f32 v192, v192
  v_mfma_f32_32x32x16_bf16 v[148:163], v[236:239], v[232:235], v[148:163]
  ds_read_b64_tr_b16 v[240:241], v7 offset:1024
  ds_read_b64_tr_b16 v[242:243], v7 offset:1088
  ds_read_b128 v[236:239], v5 offset:27136
  v_exp_f32 v193, v193
  v_exp_f32 v194, v194
  v_exp_f32 v195, v195
  v_exp_f32 v132, v132
  v_exp_f32 v133, v133
  v_smfmac_f32_32x32x32_bf16 v[212:227], v[244:247], v[188:195], v4
  s_setprio 1
  ds_read_b64_tr_b16 v[244:245], v7 offset:1280
  ds_read_b64_tr_b16 v[246:247], v7 offset:1344
  v_exp_f32 v134, v134
  v_exp_f32 v135, v135
  v_exp_f32 v136, v136
  v_mfma_f32_32x32x4_2b_bf16 v[164:195], v[250:251], v[248:249], 0
  ds_read_b64 v[250:251], v6 offset:51200
  v_exp_f32 v137, v137
  v_exp_f32 v138, v138
  v_exp_f32 v139, v139
  v_exp_f32 v140, v140
  v_exp_f32 v141, v141
  v_exp_f32 v142, v142
  v_exp_f32 v143, v143
  v_exp_f32 v144, v144
  s_add_u32 s54, s54, 4096
  buffer_load_dwordx4 v[40:43], v13, s[24:27], s54 offen offset:0 sc1
  s_waitcnt lgkmcnt(0)
  v_smfmac_f32_32x32x32_bf16 v[196:211], v[240:243], v[132:139], v4
  v_exp_f32 v145, v145
  v_exp_f32 v146, v146
  v_exp_f32 v147, v147
  v_exp_f32 v148, v148
  v_exp_f32 v149, v149
  v_smfmac_f32_32x32x32_bf16 v[196:211], v[244:247], v[140:147], v4
  v_exp_f32 v150, v150
  v_exp_f32 v151, v151
  v_exp_f32 v152, v152
  v_mfma_f32_32x32x16_bf16 v[164:179], v[236:239], v[228:231], v[164:179]
  s_setprio 0
  buffer_load_dwordx4 v[44:47], v13, s[24:27], s54 offen offset:2048 sc1
  v_exp_f32 v153, v153
  v_exp_f32 v154, v154
  v_exp_f32 v155, v155
  v_exp_f32 v156, v156
  v_exp_f32 v157, v157
  v_smfmac_f32_32x32x32_bf16 v[212:227], v[240:243], v[148:155], v4
  s_add_u32 s54, s54, 4096
  buffer_load_dwordx4 v[48:51], v13, s[24:27], s54 offen offset:0 sc1
  v_exp_f32 v158, v158
  v_exp_f32 v159, v159
  v_exp_f32 v160, v160
  v_mfma_f32_32x32x16_bf16 v[180:195], v[236:239], v[232:235], v[180:195]
  ds_read_b64_tr_b16 v[240:241], v7 offset:1536
  ds_read_b64_tr_b16 v[242:243], v7 offset:1600
  ds_read_b128 v[236:239], v5 offset:51200
  v_exp_f32 v161, v161
  v_exp_f32 v162, v162
  v_exp_f32 v163, v163
  v_exp_f32 v164, v164
  v_exp_f32 v165, v165
  v_smfmac_f32_32x32x32_bf16 v[212:227], v[244:247], v[156:163], v4
  ds_read_b64_tr_b16 v[244:245], v7 offset:1792
  ds_read_b64_tr_b16 v[246:247], v7 offset:1856
  v_exp_f32 v166, v166
  v_exp_f32 v167, v167
  v_exp_f32 v168, v168
  v_mfma_f32_32x32x4_2b_bf16 v[132:163], v[250:251], v[248:249], 0
  s_setprio 3
  ds_read_b64 v[250:251], v6 offset:51712
  v_exp_f32 v169, v169
  v_exp_f32 v170, v170
  v_exp_f32 v171, v171
  v_exp_f32 v172, v172
  v_exp_f32 v173, v173
  v_exp_f32 v174, v174
  v_exp_f32 v175, v175
  v_exp_f32 v176, v176
  buffer_load_dwordx4 v[52:55], v13, s[24:27], s54 offen offset:2048 sc1
  s_waitcnt lgkmcnt(0)
  v_smfmac_f32_32x32x32_bf16 v[196:211], v[240:243], v[164:171], v4
  v_exp_f32 v177, v177
  v_exp_f32 v178, v178
  v_exp_f32 v179, v179
  v_exp_f32 v180, v180
  v_exp_f32 v181, v181
  v_smfmac_f32_32x32x32_bf16 v[196:211], v[244:247], v[172:179], v4
  v_exp_f32 v182, v182
  v_exp_f32 v183, v183
  v_exp_f32 v184, v184
  v_mfma_f32_32x32x16_bf16 v[132:147], v[236:239], v[228:231], v[132:147]
  s_add_u32 s54, s54, 4096
  buffer_load_dwordx4 v[56:59], v13, s[24:27], s54 offen offset:0 sc1
  v_exp_f32 v185, v185
  v_exp_f32 v186, v186
  v_exp_f32 v187, v187
  v_exp_f32 v188, v188
  v_exp_f32 v189, v189
  v_smfmac_f32_32x32x32_bf16 v[212:227], v[240:243], v[180:187], v4
  buffer_load_dwordx4 v[60:63], v13, s[24:27], s54 offen offset:2048 sc1
  v_exp_f32 v190, v190
  v_exp_f32 v191, v191
  v_exp_f32 v192, v192
  v_mfma_f32_32x32x16_bf16 v[148:163], v[236:239], v[232:235], v[148:163]
  s_mov_b32 s93, 25600
  v_mad_i32_i24 v7, v8, s93, v7
  ds_read_b64_tr_b16 v[240:241], v7 offset:0
  ds_read_b64_tr_b16 v[242:243], v7 offset:64
  ds_read_b128 v[236:239], v5 offset:51712
  v_exp_f32 v193, v193
  v_exp_f32 v194, v194
  v_exp_f32 v195, v195
  v_exp_f32 v132, v132
  v_exp_f32 v133, v133
  v_smfmac_f32_32x32x32_bf16 v[212:227], v[244:247], v[188:195], v4
  ds_read_b64_tr_b16 v[244:245], v7 offset:256
  ds_read_b64_tr_b16 v[246:247], v7 offset:320
  v_exp_f32 v134, v134
  v_exp_f32 v135, v135
  v_exp_f32 v136, v136
  v_mfma_f32_32x32x4_2b_bf16 v[164:195], v[250:251], v[248:249], 0
  ds_read_b64 v[250:251], v6 offset:52224
  v_exp_f32 v137, v137
  v_exp_f32 v138, v138
  v_exp_f32 v139, v139
  v_exp_f32 v140, v140
  v_exp_f32 v141, v141
  v_exp_f32 v142, v142
  v_exp_f32 v143, v143
  v_exp_f32 v144, v144
  s_add_u32 s54, s54, 4096
  buffer_load_dwordx4 v[64:67], v13, s[24:27], s54 offen offset:0 sc1
  s_waitcnt lgkmcnt(0)
  v_smfmac_f32_32x32x32_bf16 v[196:211], v[240:243], v[132:139], v4
  v_exp_f32 v145, v145
  v_exp_f32 v146, v146
  v_exp_f32 v147, v147
  v_exp_f32 v148, v148
  v_exp_f32 v149, v149
  v_smfmac_f32_32x32x32_bf16 v[196:211], v[244:247], v[140:147], v4
  v_exp_f32 v150, v150
  v_exp_f32 v151, v151
  v_exp_f32 v152, v152
  v_mfma_f32_32x32x16_bf16 v[164:179], v[236:239], v[228:231], v[164:179]
  buffer_load_dwordx4 v[68:71], v13, s[24:27], s54 offen offset:2048 sc1
  v_exp_f32 v153, v153
  v_exp_f32 v154, v154
  v_exp_f32 v155, v155
  v_exp_f32 v156, v156
  v_exp_f32 v157, v157
  v_smfmac_f32_32x32x32_bf16 v[212:227], v[240:243], v[148:155], v4
  s_add_u32 s54, s54, 4096
  buffer_load_dwordx4 v[72:75], v13, s[24:27], s54 offen offset:0 sc1
  v_exp_f32 v158, v158
  v_exp_f32 v159, v159
  v_exp_f32 v160, v160
  v_mfma_f32_32x32x16_bf16 v[180:195], v[236:239], v[232:235], v[180:195]
  ds_read_b64_tr_b16 v[240:241], v7 offset:512
  ds_read_b64_tr_b16 v[242:243], v7 offset:576
  ds_read_b128 v[236:239], v5 offset:52224
  v_exp_f32 v161, v161
  v_exp_f32 v162, v162
  v_exp_f32 v163, v163
  v_exp_f32 v164, v164
  v_exp_f32 v165, v165
  v_smfmac_f32_32x32x32_bf16 v[212:227], v[244:247], v[156:163], v4
  ds_read_b64_tr_b16 v[244:245], v7 offset:768
  ds_read_b64_tr_b16 v[246:247], v7 offset:832
  v_exp_f32 v166, v166
  v_exp_f32 v167, v167
  v_exp_f32 v168, v168
  v_mfma_f32_32x32x4_2b_bf16 v[132:163], v[250:251], v[248:249], 0
  ds_read_b64 v[250:251], v6 offset:52736
  v_exp_f32 v169, v169
  v_exp_f32 v170, v170
  v_exp_f32 v171, v171
  v_exp_f32 v172, v172
  v_exp_f32 v173, v173
  v_exp_f32 v174, v174
  v_exp_f32 v175, v175
  v_exp_f32 v176, v176
  buffer_load_dwordx4 v[76:79], v13, s[24:27], s54 offen offset:2048 sc1
  s_waitcnt lgkmcnt(0)
  v_smfmac_f32_32x32x32_bf16 v[196:211], v[240:243], v[164:171], v4
  v_exp_f32 v177, v177
  v_exp_f32 v178, v178
  v_exp_f32 v179, v179
  v_exp_f32 v180, v180
  v_exp_f32 v181, v181
  v_smfmac_f32_32x32x32_bf16 v[196:211], v[244:247], v[172:179], v4
  v_exp_f32 v182, v182
  v_exp_f32 v183, v183
  v_exp_f32 v184, v184
  v_mfma_f32_32x32x16_bf16 v[132:147], v[236:239], v[228:231], v[132:147]
  s_add_u32 s54, s54, 4096
  buffer_load_dwordx4 v[80:83], v13, s[24:27], s54 offen offset:0 sc1
  v_exp_f32 v185, v185
  v_exp_f32 v186, v186
  v_exp_f32 v187, v187
  v_exp_f32 v188, v188
  v_exp_f32 v189, v189
  v_smfmac_f32_32x32x32_bf16 v[212:227], v[240:243], v[180:187], v4
  buffer_load_dwordx4 v[84:87], v13, s[24:27], s54 offen offset:2048 sc1
  v_exp_f32 v190, v190
  v_exp_f32 v191, v191
  v_exp_f32 v192, v192
  v_mfma_f32_32x32x16_bf16 v[148:163], v[236:239], v[232:235], v[148:163]
  ds_read_b64_tr_b16 v[240:241], v7 offset:1024
  ds_read_b64_tr_b16 v[242:243], v7 offset:1088
  ds_read_b128 v[236:239], v5 offset:52736
  v_exp_f32 v193, v193
  v_exp_f32 v194, v194
  v_exp_f32 v195, v195
  v_exp_f32 v132, v132
  v_exp_f32 v133, v133
  v_smfmac_f32_32x32x32_bf16 v[212:227], v[244:247], v[188:195], v4
  ds_read_b64_tr_b16 v[244:245], v7 offset:1280
  ds_read_b64_tr_b16 v[246:247], v7 offset:1344
  v_exp_f32 v134, v134
  v_exp_f32 v135, v135
  v_exp_f32 v136, v136
  v_mfma_f32_32x32x4_2b_bf16 v[164:195], v[250:251], v[248:249], 0
  v_add_u32 v6, 81920, v6
  ds_read_b64 v[250:251], v6 offset:51200
  v_exp_f32 v137, v137
  v_exp_f32 v138, v138
  v_exp_f32 v139, v139
  v_exp_f32 v140, v140
  v_exp_f32 v141, v141
  v_exp_f32 v142, v142
  v_exp_f32 v143, v143
  v_exp_f32 v144, v144
  s_add_u32 s54, s54, 4096
  buffer_load_dwordx4 v[88:91], v13, s[24:27], s54 offen offset:0 sc1
  s_waitcnt lgkmcnt(0)
  v_smfmac_f32_32x32x32_bf16 v[196:211], v[240:243], v[132:139], v4
  v_exp_f32 v145, v145
  v_exp_f32 v146, v146
  v_exp_f32 v147, v147
  v_exp_f32 v148, v148
  v_exp_f32 v149, v149
  v_smfmac_f32_32x32x32_bf16 v[196:211], v[244:247], v[140:147], v4
  v_exp_f32 v150, v150
  v_exp_f32 v151, v151
  v_exp_f32 v152, v152
  v_mfma_f32_32x32x16_bf16 v[164:179], v[236:239], v[228:231], v[164:179]
  buffer_load_dwordx4 v[92:95], v13, s[24:27], s54 offen offset:2048 sc1
  v_exp_f32 v153, v153
  v_exp_f32 v154, v154
  v_exp_f32 v155, v155
  v_exp_f32 v156, v156
  v_exp_f32 v157, v157
  v_smfmac_f32_32x32x32_bf16 v[212:227], v[240:243], v[148:155], v4
  s_add_u32 s54, s54, 4096
  buffer_load_dwordx4 v[96:99], v13, s[24:27], s54 offen offset:0 sc1
  v_exp_f32 v158, v158
  v_exp_f32 v159, v159
  v_exp_f32 v160, v160
  v_mfma_f32_32x32x16_bf16 v[180:195], v[236:239], v[232:235], v[180:195]
  ds_read_b64_tr_b16 v[240:241], v7 offset:1536
  ds_read_b64_tr_b16 v[242:243], v7 offset:1600
  v_add_u32 v5, 81920, v5
  ds_read_b128 v[236:239], v5 offset:51200
  v_exp_f32 v161, v161
  v_exp_f32 v162, v162
  v_exp_f32 v163, v163
  v_exp_f32 v164, v164
  v_exp_f32 v165, v165
  v_smfmac_f32_32x32x32_bf16 v[212:227], v[244:247], v[156:163], v4
  ds_read_b64_tr_b16 v[244:245], v7 offset:1792
  ds_read_b64_tr_b16 v[246:247], v7 offset:1856
  v_exp_f32 v166, v166
  v_exp_f32 v167, v167
  v_exp_f32 v168, v168
  v_mfma_f32_32x32x4_2b_bf16 v[132:163], v[250:251], v[248:249], 0
  ds_read_b64 v[250:251], v6 offset:51712
  s_setprio 2
  v_exp_f32 v169, v169
  v_exp_f32 v170, v170
  v_exp_f32 v171, v171
  v_exp_f32 v172, v172
  v_exp_f32 v173, v173
  v_exp_f32 v174, v174
  v_exp_f32 v175, v175
  v_exp_f32 v176, v176
  buffer_load_dwordx4 v[100:103], v13, s[24:27], s54 offen offset:2048 sc1
  s_waitcnt lgkmcnt(0)
  v_smfmac_f32_32x32x32_bf16 v[196:211], v[240:243], v[164:171], v4
  v_exp_f32 v177, v177
  v_exp_f32 v178, v178
  v_exp_f32 v179, v179
  v_exp_f32 v180, v180
  v_exp_f32 v181, v181
  v_smfmac_f32_32x32x32_bf16 v[196:211], v[244:247], v[172:179], v4
  v_exp_f32 v182, v182
  v_exp_f32 v183, v183
  v_exp_f32 v184, v184
  v_mfma_f32_32x32x16_bf16 v[132:147], v[236:239], v[228:231], v[132:147]
  s_add_u32 s54, s54, 4096
  buffer_load_dwordx4 v[104:107], v13, s[24:27], s54 offen offset:0 sc1
  v_exp_f32 v185, v185
  v_exp_f32 v186, v186
  v_exp_f32 v187, v187
  v_exp_f32 v188, v188
  v_exp_f32 v189, v189
  v_smfmac_f32_32x32x32_bf16 v[212:227], v[240:243], v[180:187], v4
  buffer_load_dwordx4 v[108:111], v13, s[24:27], s54 offen offset:2048 sc1
  v_exp_f32 v190, v190
  v_exp_f32 v191, v191
  v_exp_f32 v192, v192
  v_mfma_f32_32x32x16_bf16 v[148:163], v[236:239], v[232:235], v[148:163]
  s_mov_b32 s93, 81920
  v_mad_i32_i24 v7, v8, s93, v7
  ds_read_b64_tr_b16 v[240:241], v7 offset:0
  ds_read_b64_tr_b16 v[242:243], v7 offset:64
  ds_read_b128 v[236:239], v5 offset:51712
  v_exp_f32 v193, v193
  v_exp_f32 v194, v194
  v_exp_f32 v195, v195
  v_exp_f32 v132, v132
  v_exp_f32 v133, v133
  v_smfmac_f32_32x32x32_bf16 v[212:227], v[244:247], v[188:195], v4
  ds_read_b64_tr_b16 v[244:245], v7 offset:256
  ds_read_b64_tr_b16 v[246:247], v7 offset:320
  v_exp_f32 v134, v134
  v_exp_f32 v135, v135
  v_exp_f32 v136, v136
  v_mfma_f32_32x32x4_2b_bf16 v[164:195], v[250:251], v[248:249], 0
  ds_read_b64 v[250:251], v6 offset:52224
  v_exp_f32 v137, v137
  v_exp_f32 v138, v138
  v_exp_f32 v139, v139
  v_exp_f32 v140, v140
  v_exp_f32 v141, v141
  v_exp_f32 v142, v142
  v_exp_f32 v143, v143
  v_exp_f32 v144, v144
  s_add_u32 s54, s54, 4096
  buffer_load_dwordx4 v[112:115], v13, s[24:27], s54 offen offset:0 sc1
  s_waitcnt lgkmcnt(0)
  v_smfmac_f32_32x32x32_bf16 v[196:211], v[240:243], v[132:139], v4
  v_exp_f32 v145, v145
  v_exp_f32 v146, v146
  v_exp_f32 v147, v147
  v_exp_f32 v148, v148
  v_exp_f32 v149, v149
  v_smfmac_f32_32x32x32_bf16 v[196:211], v[244:247], v[140:147], v4
  v_exp_f32 v150, v150
  v_exp_f32 v151, v151
  v_exp_f32 v152, v152
  v_mfma_f32_32x32x16_bf16 v[164:179], v[236:239], v[228:231], v[164:179]
  buffer_load_dwordx4 v[116:119], v13, s[24:27], s54 offen offset:2048 sc1
  v_exp_f32 v153, v153
  v_exp_f32 v154, v154
  v_exp_f32 v155, v155
  v_exp_f32 v156, v156
  v_exp_f32 v157, v157
  v_smfmac_f32_32x32x32_bf16 v[212:227], v[240:243], v[148:155], v4
  s_add_u32 s54, s54, 4096
  buffer_load_dwordx4 v[120:123], v13, s[24:27], s54 offen offset:0 sc1
  v_exp_f32 v158, v158
  v_exp_f32 v159, v159
  v_exp_f32 v160, v160
  v_mfma_f32_32x32x16_bf16 v[180:195], v[236:239], v[232:235], v[180:195]
  ds_read_b64_tr_b16 v[240:241], v7 offset:512
  ds_read_b64_tr_b16 v[242:243], v7 offset:576
  ds_read_b128 v[236:239], v5 offset:52224
  v_exp_f32 v161, v161
  v_exp_f32 v162, v162
  v_exp_f32 v163, v163
  v_exp_f32 v164, v164
  v_exp_f32 v165, v165
  v_smfmac_f32_32x32x32_bf16 v[212:227], v[244:247], v[156:163], v4
  s_setprio 1
  ds_read_b64_tr_b16 v[244:245], v7 offset:768
  ds_read_b64_tr_b16 v[246:247], v7 offset:832
  v_exp_f32 v166, v166
  v_exp_f32 v167, v167
  v_exp_f32 v168, v168
  v_mfma_f32_32x32x4_2b_bf16 v[132:163], v[250:251], v[248:249], 0
  ds_read_b64 v[250:251], v6 offset:52736
  v_exp_f32 v169, v169
  v_exp_f32 v170, v170
  v_exp_f32 v171, v171
  v_exp_f32 v172, v172
  v_exp_f32 v173, v173
  v_exp_f32 v174, v174
  v_exp_f32 v175, v175
  v_exp_f32 v176, v176
  buffer_load_dwordx4 v[124:127], v13, s[24:27], s54 offen offset:2048 sc1
  s_waitcnt lgkmcnt(0)
  v_smfmac_f32_32x32x32_bf16 v[196:211], v[240:243], v[164:171], v4
  v_exp_f32 v177, v177
  v_exp_f32 v178, v178
  v_exp_f32 v179, v179
  v_exp_f32 v180, v180
  v_exp_f32 v181, v181
  v_smfmac_f32_32x32x32_bf16 v[196:211], v[244:247], v[172:179], v4
  v_exp_f32 v182, v182
  v_exp_f32 v183, v183
  v_exp_f32 v184, v184
  v_mfma_f32_32x32x16_bf16 v[132:147], v[236:239], v[228:231], v[132:147]
  s_setprio 0
  s_add_u32 s54, s54, 4096
  buffer_load_dwordx4 v[128:131], v13, s[24:27], s54 offen offset:0 sc1
  v_exp_f32 v185, v185
  v_exp_f32 v186, v186
  v_exp_f32 v187, v187
  v_exp_f32 v188, v188
  v_exp_f32 v189, v189
  v_smfmac_f32_32x32x32_bf16 v[212:227], v[240:243], v[180:187], v4
  buffer_load_dwordx2 v[22:23], v254, s[32:35], s57 offen
  v_exp_f32 v190, v190
  v_exp_f32 v191, v191
  v_exp_f32 v192, v192
  v_mfma_f32_32x32x16_bf16 v[148:163], v[236:239], v[232:235], v[148:163]
  ds_read_b64_tr_b16 v[240:241], v7 offset:1024
  ds_read_b64_tr_b16 v[242:243], v7 offset:1088
  ds_read_b128 v[236:239], v5 offset:52736
  v_exp_f32 v193, v193
  v_exp_f32 v194, v194
  v_exp_f32 v195, v195
  v_exp_f32 v132, v132
  v_exp_f32 v133, v133
  v_smfmac_f32_32x32x32_bf16 v[212:227], v[244:247], v[188:195], v4
  ds_read_b64_tr_b16 v[244:245], v7 offset:1280
  ds_read_b64_tr_b16 v[246:247], v7 offset:1344
  v_exp_f32 v134, v134
  v_exp_f32 v135, v135
  v_exp_f32 v136, v136
  v_mfma_f32_32x32x4_2b_bf16 v[164:195], v[250:251], v[248:249], 0
  s_waitcnt vmcnt(28)
  s_barrier
  s_setprio 3
  ds_read_b64 v[250:251], v6 offset:0
  v_exp_f32 v137, v137
  v_exp_f32 v138, v138
  v_exp_f32 v139, v139
  v_exp_f32 v140, v140
  v_exp_f32 v141, v141
  v_exp_f32 v142, v142
  v_exp_f32 v143, v143
  v_exp_f32 v144, v144
  s_add_u32 m0, s63, 0
  s_add_u32 s94, s56, 0
  buffer_load_dwordx4 v2, s[24:27], s94 offen offset:0 sc1 lds
  s_waitcnt lgkmcnt(0)
  v_smfmac_f32_32x32x32_bf16 v[196:211], v[240:243], v[132:139], v4
  v_exp_f32 v145, v145
  v_exp_f32 v146, v146
  v_exp_f32 v147, v147
  v_exp_f32 v148, v148
  v_exp_f32 v149, v149
  v_smfmac_f32_32x32x32_bf16 v[196:211], v[244:247], v[140:147], v4
  v_exp_f32 v150, v150
  v_exp_f32 v151, v151
  v_exp_f32 v152, v152
  v_mfma_f32_32x32x16_bf16 v[164:179], v[236:239], v[228:231], v[164:179]
  buffer_load_dwordx4 v2, s[24:27], s94 offen offset:1024 sc1 lds
  v_exp_f32 v153, v153
  v_exp_f32 v154, v154
  v_exp_f32 v155, v155
  v_exp_f32 v156, v156
  v_exp_f32 v157, v157
  v_smfmac_f32_32x32x32_bf16 v[212:227], v[240:243], v[148:155], v4
  buffer_load_dwordx4 v2, s[24:27], s94 offen offset:2048 sc1 lds
  v_exp_f32 v158, v158
  v_exp_f32 v159, v159
  v_exp_f32 v160, v160
  v_mfma_f32_32x32x16_bf16 v[180:195], v[236:239], v[232:235], v[180:195]
  ds_read_b64_tr_b16 v[240:241], v7 offset:1536
  ds_read_b64_tr_b16 v[242:243], v7 offset:1600
  ds_read_b128 v[236:239], v5 offset:0
  v_exp_f32 v161, v161
  v_exp_f32 v162, v162
  v_exp_f32 v163, v163
  v_exp_f32 v164, v164
  v_exp_f32 v165, v165
  v_smfmac_f32_32x32x32_bf16 v[212:227], v[244:247], v[156:163], v4
  ds_read_b64_tr_b16 v[244:245], v7 offset:1792
  ds_read_b64_tr_b16 v[246:247], v7 offset:1856
  v_exp_f32 v166, v166
  v_exp_f32 v167, v167
  v_exp_f32 v168, v168
  v_mfma_f32_32x32x4_2b_bf16 v[132:163], v[250:251], v[248:249], 0
  ds_read_b64 v[250:251], v6 offset:512
  v_exp_f32 v169, v169
  v_exp_f32 v170, v170
  v_exp_f32 v171, v171
  v_exp_f32 v172, v172
  v_exp_f32 v173, v173
  v_exp_f32 v174, v174
  v_exp_f32 v175, v175
  v_exp_f32 v176, v176
  buffer_load_dwordx4 v2, s[24:27], s94 offen offset:3072 sc1 lds
  s_waitcnt lgkmcnt(0)
  v_smfmac_f32_32x32x32_bf16 v[196:211], v[240:243], v[164:171], v4
  v_exp_f32 v177, v177
  v_exp_f32 v178, v178
  v_exp_f32 v179, v179
  v_exp_f32 v180, v180
  v_exp_f32 v181, v181
  v_smfmac_f32_32x32x32_bf16 v[196:211], v[244:247], v[172:179], v4
  v_exp_f32 v182, v182
  v_exp_f32 v183, v183
  v_exp_f32 v184, v184
  v_mfma_f32_32x32x16_bf16 v[132:147], v[236:239], v[228:231], v[132:147]
  s_add_u32 m0, s63, 4096
  s_add_u32 s94, s56, 4096
  buffer_load_dwordx4 v2, s[24:27], s94 offen offset:0 sc1 lds
  v_exp_f32 v185, v185
  v_exp_f32 v186, v186
  v_exp_f32 v187, v187
  v_exp_f32 v188, v188
  v_exp_f32 v189, v189
  v_smfmac_f32_32x32x32_bf16 v[212:227], v[240:243], v[180:187], v4
  s_add_u32 m0, s63, 40960
  s_add_u32 s94, s56, 20480
  buffer_load_dwordx4 v2, s[24:27], s94 offen offset:0 sc1 lds
  v_exp_f32 v190, v190
  v_exp_f32 v191, v191
  v_exp_f32 v192, v192
  v_mfma_f32_32x32x16_bf16 v[148:163], v[236:239], v[232:235], v[148:163]
  s_mov_b32 s93, 4294916096
  v_mad_i32_i24 v7, v8, s93, v7
  ds_read_b64_tr_b16 v[240:241], v7 offset:0
  ds_read_b64_tr_b16 v[242:243], v7 offset:64
  ds_read_b128 v[236:239], v5 offset:512
  v_exp_f32 v193, v193
  v_exp_f32 v194, v194
  v_exp_f32 v195, v195
  v_exp_f32 v132, v132
  v_exp_f32 v133, v133
  v_smfmac_f32_32x32x32_bf16 v[212:227], v[244:247], v[188:195], v4
  ds_read_b64_tr_b16 v[244:245], v7 offset:256
  ds_read_b64_tr_b16 v[246:247], v7 offset:320
  v_exp_f32 v134, v134
  v_exp_f32 v135, v135
  v_exp_f32 v136, v136
  v_mfma_f32_32x32x4_2b_bf16 v[164:195], v[250:251], v[248:249], 0
  ds_read_b64 v[250:251], v6 offset:1024
  v_exp_f32 v137, v137
  v_exp_f32 v138, v138
  v_exp_f32 v139, v139
  v_exp_f32 v140, v140
  v_exp_f32 v141, v141
  v_exp_f32 v142, v142
  v_exp_f32 v143, v143
  v_exp_f32 v144, v144
  buffer_load_dwordx4 v2, s[24:27], s94 offen offset:1024 sc1 lds
  s_waitcnt lgkmcnt(0)
  v_smfmac_f32_32x32x32_bf16 v[196:211], v[240:243], v[132:139], v4
  v_exp_f32 v145, v145
  v_exp_f32 v146, v146
  v_exp_f32 v147, v147
  v_exp_f32 v148, v148
  v_exp_f32 v149, v149
  v_smfmac_f32_32x32x32_bf16 v[196:211], v[244:247], v[140:147], v4
  v_exp_f32 v150, v150
  v_exp_f32 v151, v151
  v_exp_f32 v152, v152
  v_mfma_f32_32x32x16_bf16 v[164:179], v[236:239], v[228:231], v[164:179]
  buffer_load_dwordx4 v2, s[24:27], s94 offen offset:2048 sc1 lds
  v_exp_f32 v153, v153
  v_exp_f32 v154, v154
  v_exp_f32 v155, v155
  v_exp_f32 v156, v156
  v_exp_f32 v157, v157
  v_smfmac_f32_32x32x32_bf16 v[212:227], v[240:243], v[148:155], v4
  buffer_load_dwordx4 v2, s[24:27], s94 offen offset:3072 sc1 lds
  v_exp_f32 v158, v158
  v_exp_f32 v159, v159
  v_exp_f32 v160, v160
  v_mfma_f32_32x32x16_bf16 v[180:195], v[236:239], v[232:235], v[180:195]
  ds_read_b64_tr_b16 v[240:241], v7 offset:512
  ds_read_b64_tr_b16 v[242:243], v7 offset:576
  ds_read_b128 v[236:239], v5 offset:1024
  v_exp_f32 v161, v161
  v_exp_f32 v162, v162
  v_exp_f32 v163, v163
  v_exp_f32 v164, v164
  v_exp_f32 v165, v165
  v_smfmac_f32_32x32x32_bf16 v[212:227], v[244:247], v[156:163], v4
  ds_read_b64_tr_b16 v[244:245], v7 offset:768
  ds_read_b64_tr_b16 v[246:247], v7 offset:832
  v_exp_f32 v166, v166
  v_exp_f32 v167, v167
  v_exp_f32 v168, v168
  v_mfma_f32_32x32x4_2b_bf16 v[132:163], v[250:251], v[248:249], 0
  ds_read_b64 v[250:251], v6 offset:1536
  s_setprio 2
  v_exp_f32 v169, v169
  v_exp_f32 v170, v170
  v_exp_f32 v171, v171
  v_exp_f32 v172, v172
  v_exp_f32 v173, v173
  v_exp_f32 v174, v174
  v_exp_f32 v175, v175
  v_exp_f32 v176, v176
  s_add_u32 m0, s63, 45056
  s_add_u32 s94, s56, 24576
  buffer_load_dwordx4 v2, s[24:27], s94 offen offset:0 sc1 lds
  s_waitcnt lgkmcnt(0)
  v_smfmac_f32_32x32x32_bf16 v[196:211], v[240:243], v[164:171], v4
  v_exp_f32 v177, v177
  v_exp_f32 v178, v178
  v_exp_f32 v179, v179
  v_exp_f32 v180, v180
  v_exp_f32 v181, v181
  v_smfmac_f32_32x32x32_bf16 v[196:211], v[244:247], v[172:179], v4
  v_exp_f32 v182, v182
  v_exp_f32 v183, v183
  v_exp_f32 v184, v184
  v_mfma_f32_32x32x16_bf16 v[132:147], v[236:239], v[228:231], v[132:147]
  s_bfe_u32 s37, s2, 0x30003
  s_lshl2_add_u32 s37, s37, s39
  s_mul_i32 s37, s37, 4736
  s_mul_i32 s38, s39, 5120
  s_sub_u32 s37, s37, s38
  s_add_u32 s37, s37, s56
  s_add_u32 s37, s37, 40960
  v_min_u32 v19, 36, v1
  v_lshlrev_b32 v19, 7, v19
  buffer_load_dword v9, v19, s[24:27], s37 offen sc1
  v_exp_f32 v185, v185
  v_exp_f32 v186, v186
  v_exp_f32 v187, v187
  v_exp_f32 v188, v188
  v_exp_f32 v189, v189
  v_smfmac_f32_32x32x32_bf16 v[212:227], v[240:243], v[180:187], v4
  v_exp_f32 v190, v190
  v_exp_f32 v191, v191
  v_exp_f32 v192, v192
  v_mfma_f32_32x32x16_bf16 v[148:163], v[236:239], v[232:235], v[148:163]
  ds_read_b64_tr_b16 v[240:241], v7 offset:1024
  ds_read_b64_tr_b16 v[242:243], v7 offset:1088
  ds_read_b128 v[236:239], v5 offset:1536
  v_exp_f32 v193, v193
  v_exp_f32 v194, v194
  v_exp_f32 v195, v195
  v_exp_f32 v132, v132
  v_exp_f32 v133, v133
  v_smfmac_f32_32x32x32_bf16 v[212:227], v[244:247], v[188:195], v4
  ds_read_b64_tr_b16 v[244:245], v7 offset:1280
  ds_read_b64_tr_b16 v[246:247], v7 offset:1344
  v_exp_f32 v134, v134
  v_exp_f32 v135, v135
  v_exp_f32 v136, v136
  v_mfma_f32_32x32x4_2b_bf16 v[164:195], v[250:251], v[248:249], 0
  ds_read_b64 v[250:251], v6 offset:25600
  v_exp_f32 v137, v137
  v_exp_f32 v138, v138
  v_exp_f32 v139, v139
  v_exp_f32 v140, v140
  v_exp_f32 v141, v141
  v_exp_f32 v142, v142
  v_exp_f32 v143, v143
  v_exp_f32 v144, v144
  s_waitcnt lgkmcnt(0)
  v_smfmac_f32_32x32x32_bf16 v[196:211], v[240:243], v[132:139], v4
  v_exp_f32 v145, v145
  v_exp_f32 v146, v146
  v_exp_f32 v147, v147
  v_exp_f32 v148, v148
  v_exp_f32 v149, v149
  v_smfmac_f32_32x32x32_bf16 v[196:211], v[244:247], v[140:147], v4
  v_exp_f32 v150, v150
  v_exp_f32 v151, v151
  v_exp_f32 v152, v152
  v_mfma_f32_32x32x16_bf16 v[164:179], v[236:239], v[228:231], v[164:179]
  v_exp_f32 v153, v153
  v_exp_f32 v154, v154
  v_exp_f32 v155, v155
  v_exp_f32 v156, v156
  v_exp_f32 v157, v157
  v_smfmac_f32_32x32x32_bf16 v[212:227], v[240:243], v[148:155], v4
  v_exp_f32 v158, v158
  v_exp_f32 v159, v159
  v_exp_f32 v160, v160
  v_mfma_f32_32x32x16_bf16 v[180:195], v[236:239], v[232:235], v[180:195]
  ds_read_b64_tr_b16 v[240:241], v7 offset:1536
  ds_read_b64_tr_b16 v[242:243], v7 offset:1600
  ds_read_b128 v[236:239], v5 offset:25600
  v_exp_f32 v161, v161
  v_exp_f32 v162, v162
  v_exp_f32 v163, v163
  v_exp_f32 v164, v164
  v_exp_f32 v165, v165
  v_smfmac_f32_32x32x32_bf16 v[212:227], v[244:247], v[156:163], v4
  s_setprio 1
  ds_read_b64_tr_b16 v[244:245], v7 offset:1792
  ds_read_b64_tr_b16 v[246:247], v7 offset:1856
  v_exp_f32 v166, v166
  v_exp_f32 v167, v167
  v_exp_f32 v168, v168
  v_mfma_f32_32x32x4_2b_bf16 v[132:163], v[250:251], v[248:249], 0
  ds_read_b64 v[250:251], v6 offset:26112
  v_exp_f32 v169, v169
  v_exp_f32 v170, v170
  v_exp_f32 v171, v171
  v_exp_f32 v172, v172
  v_exp_f32 v173, v173
  v_exp_f32 v174, v174
  v_exp_f32 v175, v175
  v_exp_f32 v176, v176
  s_waitcnt lgkmcnt(0)
  v_smfmac_f32_32x32x32_bf16 v[196:211], v[240:243], v[164:171], v4
  v_exp_f32 v177, v177
  v_exp_f32 v178, v178
  v_exp_f32 v179, v179
  v_exp_f32 v180, v180
  v_exp_f32 v181, v181
  v_smfmac_f32_32x32x32_bf16 v[196:211], v[244:247], v[172:179], v4
  v_exp_f32 v182, v182
  v_exp_f32 v183, v183
  v_exp_f32 v184, v184
  v_mfma_f32_32x32x16_bf16 v[132:147], v[236:239], v[228:231], v[132:147]
  s_setprio 0
  v_exp_f32 v185, v185
  v_exp_f32 v186, v186
  v_exp_f32 v187, v187
  v_exp_f32 v188, v188
  v_exp_f32 v189, v189
  v_smfmac_f32_32x32x32_bf16 v[212:227], v[240:243], v[180:187], v4
  v_exp_f32 v190, v190
  v_exp_f32 v191, v191
  v_exp_f32 v192, v192
  v_mfma_f32_32x32x16_bf16 v[148:163], v[236:239], v[232:235], v[148:163]
  s_mov_b32 s93, 25600
  v_mad_i32_i24 v7, v8, s93, v7
  ds_read_b64_tr_b16 v[240:241], v7 offset:0
  ds_read_b64_tr_b16 v[242:243], v7 offset:64
  ds_read_b128 v[236:239], v5 offset:26112
  v_exp_f32 v193, v193
  v_exp_f32 v194, v194
  v_exp_f32 v195, v195
  v_exp_f32 v132, v132
  v_exp_f32 v133, v133
  v_smfmac_f32_32x32x32_bf16 v[212:227], v[244:247], v[188:195], v4
  ds_read_b64_tr_b16 v[244:245], v7 offset:256
  ds_read_b64_tr_b16 v[246:247], v7 offset:320
  v_exp_f32 v134, v134
  v_exp_f32 v135, v135
  v_exp_f32 v136, v136
  v_mfma_f32_32x32x4_2b_bf16 v[164:195], v[250:251], v[248:249], 0
  s_barrier
  s_setprio 3
  ds_read_b64 v[250:251], v6 offset:26624
  v_exp_f32 v137, v137
  v_exp_f32 v138, v138
  v_exp_f32 v139, v139
  v_exp_f32 v140, v140
  v_exp_f32 v141, v141
  v_exp_f32 v142, v142
  v_exp_f32 v143, v143
  v_exp_f32 v144, v144
  s_add_u32 m0, s63, 81920
  s_add_u32 s94, s56, 40960
  s_cmp_gt_u32 s3, 4
  s_cselect_b64 vcc, -1, 0
  s_cbranch_vccnz L_w2p0
  buffer_load_dwordx4 v2, s[24:27], s94 offen offset:0 sc1 lds
L_w2p0:
  s_waitcnt lgkmcnt(0)
  v_smfmac_f32_32x32x32_bf16 v[196:211], v[240:243], v[132:139], v4
  v_exp_f32 v145, v145
  v_exp_f32 v146, v146
  v_exp_f32 v147, v147
  v_exp_f32 v148, v148
  v_exp_f32 v149, v149
  v_smfmac_f32_32x32x32_bf16 v[196:211], v[244:247], v[140:147], v4
  v_exp_f32 v150, v150
  v_exp_f32 v151, v151
  v_exp_f32 v152, v152
  v_mfma_f32_32x32x16_bf16 v[164:179], v[236:239], v[228:231], v[164:179]
  s_cbranch_vccnz L_w2p1
  buffer_load_dwordx4 v2, s[24:27], s94 offen offset:1024 sc1 lds
L_w2p1:
  v_exp_f32 v153, v153
  v_exp_f32 v154, v154
  v_exp_f32 v155, v155
  v_exp_f32 v156, v156
  v_exp_f32 v157, v157
  v_smfmac_f32_32x32x32_bf16 v[212:227], v[240:243], v[148:155], v4
  s_cbranch_vccnz L_w2p2
  buffer_load_dwordx4 v2, s[24:27], s94 offen offset:2048 sc1 lds
L_w2p2:
  v_exp_f32 v158, v158
  v_exp_f32 v159, v159
  v_exp_f32 v160, v160
  v_mfma_f32_32x32x16_bf16 v[180:195], v[236:239], v[232:235], v[180:195]
  ds_read_b64_tr_b16 v[240:241], v7 offset:512
  ds_read_b64_tr_b16 v[242:243], v7 offset:576
  ds_read_b128 v[236:239], v5 offset:26624
  v_exp_f32 v161, v161
  v_exp_f32 v162, v162
  v_exp_f32 v163, v163
  v_exp_f32 v164, v164
  v_exp_f32 v165, v165
  v_smfmac_f32_32x32x32_bf16 v[212:227], v[244:247], v[156:163], v4
  s_setprio 2
  ds_read_b64_tr_b16 v[244:245], v7 offset:768
  ds_read_b64_tr_b16 v[246:247], v7 offset:832
  v_exp_f32 v166, v166
  v_exp_f32 v167, v167
  v_exp_f32 v168, v168
  v_mfma_f32_32x32x4_2b_bf16 v[132:163], v[250:251], v[248:249], 0
  ds_read_b64 v[250:251], v6 offset:27136
  v_exp_f32 v169, v169
  v_exp_f32 v170, v170
  v_exp_f32 v171, v171
  v_exp_f32 v172, v172
  v_exp_f32 v173, v173
  v_exp_f32 v174, v174
  v_exp_f32 v175, v175
  v_exp_f32 v176, v176
  s_cbranch_vccnz L_w2p3
  buffer_load_dwordx4 v2, s[24:27], s94 offen offset:3072 sc1 lds
L_w2p3:
  s_waitcnt lgkmcnt(0)
  v_smfmac_f32_32x32x32_bf16 v[196:211], v[240:243], v[164:171], v4
  v_exp_f32 v177, v177
  v_exp_f32 v178, v178
  v_exp_f32 v179, v179
  v_exp_f32 v180, v180
  v_exp_f32 v181, v181
  v_smfmac_f32_32x32x32_bf16 v[196:211], v[244:247], v[172:179], v4
  v_exp_f32 v182, v182
  v_exp_f32 v183, v183
  v_exp_f32 v184, v184
  v_mfma_f32_32x32x16_bf16 v[132:147], v[236:239], v[228:231], v[132:147]
  s_add_u32 m0, s63, 86016
  s_add_u32 s94, s56, 45056
  s_cbranch_vccnz L_w2p4
  buffer_load_dwordx4 v2, s[24:27], s94 offen offset:0 sc1 lds
L_w2p4:
  v_exp_f32 v185, v185
  v_exp_f32 v186, v186
  v_exp_f32 v187, v187
  v_exp_f32 v188, v188
  v_exp_f32 v189, v189
  v_smfmac_f32_32x32x32_bf16 v[212:227], v[240:243], v[180:187], v4
  v_exp_f32 v190, v190
  v_exp_f32 v191, v191
  v_exp_f32 v192, v192
  v_mfma_f32_32x32x16_bf16 v[148:163], v[236:239], v[232:235], v[148:163]
  ds_read_b64_tr_b16 v[240:241], v7 offset:1024
  ds_read_b64_tr_b16 v[242:243], v7 offset:1088
  ds_read_b128 v[236:239], v5 offset:27136
  v_exp_f32 v193, v193
  v_exp_f32 v194, v194
  v_exp_f32 v195, v195
  v_exp_f32 v132, v132
  v_exp_f32 v133, v133
  v_smfmac_f32_32x32x32_bf16 v[212:227], v[244:247], v[188:195], v4
  ds_read_b64_tr_b16 v[244:245], v7 offset:1280
  ds_read_b64_tr_b16 v[246:247], v7 offset:1344
  v_exp_f32 v134, v134
  v_exp_f32 v135, v135
  v_exp_f32 v136, v136
  v_mfma_f32_32x32x4_2b_bf16 v[164:195], v[250:251], v[248:249], 0
  v_exp_f32 v137, v137
  v_exp_f32 v138, v138
  v_exp_f32 v139, v139
  v_exp_f32 v140, v140
  v_exp_f32 v141, v141
  v_exp_f32 v142, v142
  v_exp_f32 v143, v143
  v_exp_f32 v144, v144
  s_waitcnt lgkmcnt(0)
  v_smfmac_f32_32x32x32_bf16 v[196:211], v[240:243], v[132:139], v4
  v_exp_f32 v145, v145
  v_exp_f32 v146, v146
  v_exp_f32 v147, v147
  v_exp_f32 v148, v148
  v_exp_f32 v149, v149
  v_smfmac_f32_32x32x32_bf16 v[196:211], v[244:247], v[140:147], v4
  v_exp_f32 v150, v150
  v_exp_f32 v151, v151
  v_exp_f32 v152, v152
  v_mfma_f32_32x32x16_bf16 v[164:179], v[236:239], v[228:231], v[164:179]
  s_setprio 1
  v_exp_f32 v153, v153
  v_exp_f32 v154, v154
  v_exp_f32 v155, v155
  v_exp_f32 v156, v156
  v_exp_f32 v157, v157
  v_smfmac_f32_32x32x32_bf16 v[212:227], v[240:243], v[148:155], v4
  v_exp_f32 v158, v158
  v_exp_f32 v159, v159
  v_exp_f32 v160, v160
  s_mul_i32 s37, s3, 3200
  s_add_u32 s37, s37, 133120
  v_add_u32 v17, s37, v2
  s_xor_b32 s38, s3, 4
  s_mul_i32 s38, s38, 3200
  s_add_u32 s38, s38, 133120
  v_add_u32 v18, s38, v2
  v_mfma_f32_32x32x16_bf16 v[180:195], v[236:239], v[232:235], v[180:195]
  ds_read_b64_tr_b16 v[240:241], v7 offset:1536
  ds_read_b64_tr_b16 v[242:243], v7 offset:1600
  v_exp_f32 v161, v161
  v_exp_f32 v162, v162
  v_exp_f32 v163, v163
  v_exp_f32 v164, v164
  v_exp_f32 v165, v165
  v_smfmac_f32_32x32x32_bf16 v[212:227], v[244:247], v[156:163], v4
  ds_read_b64_tr_b16 v[244:245], v7 offset:1792
  ds_read_b64_tr_b16 v[246:247], v7 offset:1856
  v_exp_f32 v166, v166
  v_exp_f32 v167, v167
  v_exp_f32 v168, v168
  v_exp_f32 v169, v169
  v_exp_f32 v170, v170
  v_exp_f32 v171, v171
  v_exp_f32 v172, v172
  v_exp_f32 v173, v173
  v_exp_f32 v174, v174
  v_exp_f32 v175, v175
  v_exp_f32 v176, v176
  s_waitcnt lgkmcnt(0)
  v_smfmac_f32_32x32x32_bf16 v[196:211], v[240:243], v[164:171], v4
  s_setprio 0
  v_exp_f32 v177, v177
  v_exp_f32 v178, v178
  v_exp_f32 v179, v179
  v_exp_f32 v180, v180
  v_exp_f32 v181, v181
  v_smfmac_f32_32x32x32_bf16 v[196:211], v[244:247], v[172:179], v4
  v_exp_f32 v182, v182
  v_exp_f32 v183, v183
  v_exp_f32 v184, v184
  v_exp_f32 v185, v185
  v_exp_f32 v186, v186
  v_exp_f32 v187, v187
  v_exp_f32 v188, v188
  v_exp_f32 v189, v189
  v_smfmac_f32_32x32x32_bf16 v[212:227], v[240:243], v[180:187], v4
  v_exp_f32 v190, v190
  v_exp_f32 v191, v191
  v_exp_f32 v192, v192
  ds_write_b128 v17, v[196:199] offset:0
  ds_write_b128 v17, v[200:203] offset:1024
  ds_write_b128 v17, v[204:207] offset:2048
  v_exp_f32 v193, v193
  v_exp_f32 v194, v194
  v_exp_f32 v195, v195
  s_nop 1
  v_smfmac_f32_32x32x32_bf16 v[212:227], v[244:247], v[188:195], v4
  s_waitcnt vmcnt(0)
  s_waitcnt lgkmcnt(0)
  s_barrier
  ds_read_b128 v[132:135], v18 offset:0
  ds_read_b128 v[136:139], v18 offset:1024
  ds_read_b128 v[140:143], v18 offset:2048
  s_cmp_le_u32 s3, 4
  s_cbranch_scc1 L_w2q
  s_add_u32 m0, s63, 81920
  s_add_u32 s94, s56, 40960
  buffer_load_dwordx4 v2, s[24:27], s94 offen offset:0 sc1 lds
  buffer_load_dwordx4 v2, s[24:27], s94 offen offset:1024 sc1 lds
  buffer_load_dwordx4 v2, s[24:27], s94 offen offset:2048 sc1 lds
  buffer_load_dwordx4 v2, s[24:27], s94 offen offset:3072 sc1 lds
  s_add_u32 m0, s63, 86016
  s_add_u32 s94, s56, 45056
  buffer_load_dwordx4 v2, s[24:27], s94 offen offset:0 sc1 lds
L_w2q:
  ds_read_b128 v[164:167], v11 offset:0
  ds_read_b128 v[168:171], v11 offset:1024
  ds_read_b128 v[172:175], v11 offset:2048
  s_waitcnt lgkmcnt(3)
  v_pk_add_f32 v[140:141], v[140:141], v[220:221]
  v_pk_add_f32 v[132:133], v[132:133], v[212:213]
  v_pk_add_f32 v[134:135], v[134:135], v[214:215]
  v_pk_add_f32 v[136:137], v[136:137], v[216:217]
  v_pk_add_f32 v[138:139], v[138:139], v[218:219]
  v_pk_add_f32 v[142:143], v[142:143], v[222:223]
  v_mov_b32 v144, v140
  v_mov_b32 v145, v140
  v_pk_mul_f32 v[146:147], v[132:133], 0 op_sel_hi:[1,0]
  ds_read_b128 v[176:179], v11 offset:3072
  ds_read_b128 v[180:183], v11 offset:4096
  v_permlane32_swap_b32 v145, v144
  v_pk_fma_f32 v[146:147], v[134:135], 0, v[146:147] op_sel_hi:[1,0,1]
  ds_read_b128 v[184:187], v11 offset:5120
  v_pk_fma_f32 v[146:147], v[136:137], 0, v[146:147] op_sel_hi:[1,0,1]
  ds_read_b128 v[188:191], v11 offset:6144
  v_pk_fma_f32 v[146:147], v[138:139], 0, v[146:147] op_sel_hi:[1,0,1]
  ds_read_b128 v[192:195], v11 offset:7168
  v_pk_fma_f32 v[146:147], v[140:141], 0, v[146:147] op_sel_hi:[1,0,1]
  ds_read_b128 v[196:199], v11 offset:8192
  v_pk_fma_f32 v[146:147], v[142:143], 0, v[146:147] op_sel_hi:[1,0,1]
  ds_read_b128 v[200:203], v11 offset:9216
  v_add_f32 v146, v146, v147
  v_add_f32 v146, v146, v144
  v_cmp_nle_f32 vcc, 0x1f800000, v146
  s_nop 0
  s_mov_b64 s[90:91], vcc
  v_cmp_nge_f32 vcc, 0x5f800000, v146
  s_nop 0
  s_or_b64 vcc, vcc, s[90:91]
  s_cbranch_scc1 L_slow
L_slow_done:
  v_rcp_f32 v145, v144
  s_nop 0
  v_pk_mul_f32 v[132:133], v[132:133], v[144:145] op_sel:[0,1] op_sel_hi:[1,1]
  v_pk_mul_f32 v[134:135], v[134:135], v[144:145] op_sel:[0,1] op_sel_hi:[1,1]
  v_pk_mul_f32 v[136:137], v[136:137], v[144:145] op_sel:[0,1] op_sel_hi:[1,1]
  v_pk_mul_f32 v[138:139], v[138:139], v[144:145] op_sel:[0,1] op_sel_hi:[1,1]
  v_pk_mul_f32 v[140:141], v[140:141], v[144:145] op_sel:[0,1] op_sel_hi:[1,1]
  v_pk_mul_f32 v[142:143], v[142:143], v[144:145] op_sel:[0,1] op_sel_hi:[1,1]
  v_cvt_pk_bf16_f32 v148, v132, v133
  v_cvt_pk_bf16_f32 v149, v134, v135
  v_cvt_pk_bf16_f32 v150, v136, v137
  v_cvt_pk_bf16_f32 v151, v138, v139
  v_cvt_pk_bf16_f32 v152, v140, v141
  v_cvt_pk_bf16_f32 v153, v142, v143
  buffer_store_dwordx4 v[148:151], v2, s[24:27], s51 offen sc1
  s_mov_b32 exec_hi, 0
  buffer_store_dwordx2 v[152:153], v2, s[24:27], s52 offen sc1
  s_mov_b64 exec, -1
L_w2r:
  s_waitcnt lgkmcnt(5)
  v_mfma_f32_16x16x32_bf16 v[204:207], v[164:167], v[24:27], 0
  ds_read_b128 v[164:167], v11 offset:10240
  v_add_u32 v12, 81920, v11
  v_mfma_f32_16x16x32_bf16 v[208:211], v[168:171], v[24:27], 0
  ds_read_b128 v[168:171], v11 offset:11264
  v_and_b32 v10, 63, v1
  v_mfma_f32_16x16x32_bf16 v[212:215], v[172:175], v[24:27], 0
  ds_read_b128 v[172:175], v11 offset:12288
  v_lshlrev_b32 v10, 2, v10
  v_mfma_f32_16x16x32_bf16 v[216:219], v[176:179], v[24:27], 0
  ds_read_b128 v[176:179], v11 offset:13312
  v_lshlrev_b32 v8, 4, v0
  v_mfma_f32_16x16x32_bf16 v[220:223], v[180:183], v[24:27], 0
  ds_read_b128 v[180:183], v11 offset:14336
  v_add_u32 v8, 40960, v8
  s_waitcnt lgkmcnt(5)
  v_mfma_f32_16x16x32_bf16 v[204:207], v[184:187], v[28:31], v[204:207]
  ds_read_b128 v[184:187], v11 offset:15360
  v_lshlrev_b32 v9, 3, v0
  v_mfma_f32_16x16x32_bf16 v[208:211], v[188:191], v[28:31], v[208:211]
  ds_read_b128 v[188:191], v11 offset:16384
  v_add_u32 v9, 57344, v9
  v_mfma_f32_16x16x32_bf16 v[212:215], v[192:195], v[28:31], v[212:215]
  ds_read_b128 v[192:195], v11 offset:17408
  v_mfma_f32_16x16x32_bf16 v[216:219], v[196:199], v[28:31], v[216:219]
  ds_read_b128 v[196:199], v11 offset:18432
  v_mfma_f32_16x16x32_bf16 v[220:223], v[200:203], v[28:31], v[220:223]
  ds_read_b128 v[200:203], v11 offset:19456
  s_barrier
  s_waitcnt lgkmcnt(5)
  v_mfma_f32_16x16x32_bf16 v[204:207], v[164:167], v[32:35], v[204:207]
  ds_read_b128 v[164:167], v11 offset:40960
  v_mfma_f32_16x16x32_bf16 v[208:211], v[168:171], v[32:35], v[208:211]
  ds_read_b128 v[168:171], v11 offset:41984
  v_mfma_f32_16x16x32_bf16 v[212:215], v[172:175], v[32:35], v[212:215]
  ds_read_b128 v[172:175], v11 offset:43008
  s_add_u32 m0, s63, 122880
  s_add_u32 s94, s56, 61440
  buffer_load_dwordx4 v2, s[24:27], s94 offen offset:0 sc1 lds
  v_mfma_f32_16x16x32_bf16 v[216:219], v[176:179], v[32:35], v[216:219]
  ds_read_b128 v[176:179], v11 offset:44032
  v_mfma_f32_16x16x32_bf16 v[220:223], v[180:183], v[32:35], v[220:223]
  ds_read_b128 v[180:183], v11 offset:45056
  s_waitcnt lgkmcnt(5)
  v_mfma_f32_16x16x32_bf16 v[204:207], v[184:187], v[36:39], v[204:207]
  ds_read_b128 v[184:187], v11 offset:46080
  buffer_load_dwordx4 v2, s[24:27], s94 offen offset:1024 sc1 lds
  v_mfma_f32_16x16x32_bf16 v[208:211], v[188:191], v[36:39], v[208:211]
  ds_read_b128 v[188:191], v11 offset:47104
  v_mfma_f32_16x16x32_bf16 v[212:215], v[192:195], v[36:39], v[212:215]
  ds_read_b128 v[192:195], v11 offset:48128
  v_mfma_f32_16x16x32_bf16 v[216:219], v[196:199], v[36:39], v[216:219]
  ds_read_b128 v[196:199], v11 offset:49152
  buffer_load_dwordx4 v2, s[24:27], s94 offen offset:2048 sc1 lds
  v_mfma_f32_16x16x32_bf16 v[220:223], v[200:203], v[36:39], v[220:223]
  ds_read_b128 v[200:203], v11 offset:50176
  s_waitcnt vmcnt(3)
  s_mov_b64 exec, 1
  buffer_store_dword v3, off, s[24:27], s53 offset:0 sc1
  s_mov_b64 exec, -1
  s_waitcnt lgkmcnt(5)
  v_mfma_f32_16x16x32_bf16 v[204:207], v[164:167], v[40:43], v[204:207]
  ds_read_b128 v[164:167], v11 offset:51200
  v_mfma_f32_16x16x32_bf16 v[208:211], v[168:171], v[40:43], v[208:211]
  ds_read_b128 v[168:171], v11 offset:52224
  buffer_load_dwordx4 v2, s[24:27], s94 offen offset:3072 sc1 lds
  v_mfma_f32_16x16x32_bf16 v[212:215], v[172:175], v[40:43], v[212:215]
  ds_read_b128 v[172:175], v11 offset:53248
  v_mfma_f32_16x16x32_bf16 v[216:219], v[176:179], v[40:43], v[216:219]
  ds_read_b128 v[176:179], v11 offset:54272
  v_mfma_f32_16x16x32_bf16 v[220:223], v[180:183], v[40:43], v[220:223]
  ds_read_b128 v[180:183], v11 offset:55296
  s_add_u32 m0, s63, 126976
  s_add_u32 s94, s56, 65536
  buffer_load_dwordx4 v2, s[24:27], s94 offen offset:0 sc1 lds
  s_waitcnt lgkmcnt(5)
  v_mfma_f32_16x16x32_bf16 v[204:207], v[184:187], v[44:47], v[204:207]
  ds_read_b128 v[184:187], v11 offset:56320
  v_mfma_f32_16x16x32_bf16 v[208:211], v[188:191], v[44:47], v[208:211]
  ds_read_b128 v[188:191], v11 offset:57344
  v_mfma_f32_16x16x32_bf16 v[212:215], v[192:195], v[44:47], v[212:215]
  ds_read_b128 v[192:195], v11 offset:58368
  v_mfma_f32_16x16x32_bf16 v[216:219], v[196:199], v[44:47], v[216:219]
  ds_read_b128 v[196:199], v11 offset:59392
  v_mfma_f32_16x16x32_bf16 v[220:223], v[200:203], v[44:47], v[220:223]
  ds_read_b128 v[200:203], v11 offset:60416
  s_waitcnt vmcnt(6)
  s_barrier
  s_waitcnt lgkmcnt(5)
  v_mfma_f32_16x16x32_bf16 v[204:207], v[164:167], v[48:51], v[204:207]
  ds_read_b128 v[164:167], v12 offset:0
  s_add_u32 m0, s63, 0
  s_add_u32 s94, s56, 81920
  buffer_load_dwordx4 v2, s[24:27], s94 offen offset:0 sc1 lds
  v_mfma_f32_16x16x32_bf16 v[208:211], v[168:171], v[48:51], v[208:211]
  ds_read_b128 v[168:171], v12 offset:1024
  v_mfma_f32_16x16x32_bf16 v[212:215], v[172:175], v[48:51], v[212:215]
  ds_read_b128 v[172:175], v12 offset:2048
  v_mfma_f32_16x16x32_bf16 v[216:219], v[176:179], v[48:51], v[216:219]
  ds_read_b128 v[176:179], v12 offset:3072
  buffer_load_dwordx4 v2, s[24:27], s94 offen offset:1024 sc1 lds
  v_mfma_f32_16x16x32_bf16 v[220:223], v[180:183], v[48:51], v[220:223]
  ds_read_b128 v[180:183], v12 offset:4096
  s_waitcnt lgkmcnt(5)
  v_mfma_f32_16x16x32_bf16 v[204:207], v[184:187], v[52:55], v[204:207]
  ds_read_b128 v[184:187], v12 offset:5120
  v_mfma_f32_16x16x32_bf16 v[208:211], v[188:191], v[52:55], v[208:211]
  ds_read_b128 v[188:191], v12 offset:6144
  buffer_load_dwordx4 v2, s[24:27], s94 offen offset:2048 sc1 lds
  v_mfma_f32_16x16x32_bf16 v[212:215], v[192:195], v[52:55], v[212:215]
  ds_read_b128 v[192:195], v12 offset:7168
  v_mfma_f32_16x16x32_bf16 v[216:219], v[196:199], v[52:55], v[216:219]
  ds_read_b128 v[196:199], v12 offset:8192
  v_mfma_f32_16x16x32_bf16 v[220:223], v[200:203], v[52:55], v[220:223]
  ds_read_b128 v[200:203], v12 offset:9216
  buffer_load_dwordx4 v2, s[24:27], s94 offen offset:3072 sc1 lds
  s_waitcnt lgkmcnt(5)
  v_mfma_f32_16x16x32_bf16 v[204:207], v[164:167], v[56:59], v[204:207]
  ds_read_b128 v[164:167], v12 offset:10240
  v_mfma_f32_16x16x32_bf16 v[208:211], v[168:171], v[56:59], v[208:211]
  ds_read_b128 v[168:171], v12 offset:11264
  v_mfma_f32_16x16x32_bf16 v[212:215], v[172:175], v[56:59], v[212:215]
  ds_read_b128 v[172:175], v12 offset:12288
  s_add_u32 m0, s63, 4096
  s_add_u32 s94, s56, 86016
  buffer_load_dwordx4 v2, s[24:27], s94 offen offset:0 sc1 lds
  v_mfma_f32_16x16x32_bf16 v[216:219], v[176:179], v[56:59], v[216:219]
  ds_read_b128 v[176:179], v12 offset:13312
  v_mfma_f32_16x16x32_bf16 v[220:223], v[180:183], v[56:59], v[220:223]
  ds_read_b128 v[180:183], v12 offset:14336
  s_waitcnt lgkmcnt(5)
  v_mfma_f32_16x16x32_bf16 v[204:207], v[184:187], v[60:63], v[204:207]
  ds_read_b128 v[184:187], v12 offset:15360
  v_mfma_f32_16x16x32_bf16 v[208:211], v[188:191], v[60:63], v[208:211]
  ds_read_b128 v[188:191], v12 offset:16384
  v_mfma_f32_16x16x32_bf16 v[212:215], v[192:195], v[60:63], v[212:215]
  ds_read_b128 v[192:195], v12 offset:17408
  v_mfma_f32_16x16x32_bf16 v[216:219], v[196:199], v[60:63], v[216:219]
  ds_read_b128 v[196:199], v12 offset:18432
  v_mfma_f32_16x16x32_bf16 v[220:223], v[200:203], v[60:63], v[220:223]
  ds_read_b128 v[200:203], v12 offset:19456
  s_waitcnt vmcnt(5)
  s_barrier
  s_waitcnt lgkmcnt(5)
  v_mfma_f32_16x16x32_bf16 v[204:207], v[164:167], v[64:67], v[204:207]
  ds_read_b128 v[164:167], v12 offset:40960
  v_mfma_f32_16x16x32_bf16 v[208:211], v[168:171], v[64:67], v[208:211]
  ds_read_b128 v[168:171], v12 offset:41984
  s_add_u32 m0, s63, 40960
  s_add_u32 s94, s56, 102400
  buffer_load_dwordx4 v2, s[24:27], s94 offen offset:0 sc1 lds
  v_mfma_f32_16x16x32_bf16 v[212:215], v[172:175], v[64:67], v[212:215]
  ds_read_b128 v[172:175], v12 offset:43008
  v_mfma_f32_16x16x32_bf16 v[216:219], v[176:179], v[64:67], v[216:219]
  ds_read_b128 v[176:179], v12 offset:44032
  v_mfma_f32_16x16x32_bf16 v[220:223], v[180:183], v[64:67], v[220:223]
  ds_read_b128 v[180:183], v12 offset:45056
  buffer_load_dwordx4 v2, s[24:27], s94 offen offset:1024 sc1 lds
  s_waitcnt lgkmcnt(5)
  v_mfma_f32_16x16x32_bf16 v[204:207], v[184:187], v[68:71], v[204:207]
  ds_read_b128 v[184:187], v12 offset:46080
  v_mfma_f32_16x16x32_bf16 v[208:211], v[188:191], v[68:71], v[208:211]
  ds_read_b128 v[188:191], v12 offset:47104
  v_mfma_f32_16x16x32_bf16 v[212:215], v[192:195], v[68:71], v[212:215]
  ds_read_b128 v[192:195], v12 offset:48128
  buffer_load_dwordx4 v2, s[24:27], s94 offen offset:2048 sc1 lds
  v_mfma_f32_16x16x32_bf16 v[216:219], v[196:199], v[68:71], v[216:219]
  ds_read_b128 v[196:199], v12 offset:49152
  v_mfma_f32_16x16x32_bf16 v[220:223], v[200:203], v[68:71], v[220:223]
  ds_read_b128 v[200:203], v12 offset:50176
  s_waitcnt lgkmcnt(5)
  v_mfma_f32_16x16x32_bf16 v[204:207], v[164:167], v[72:75], v[204:207]
  ds_read_b128 v[164:167], v12 offset:51200
  buffer_load_dwordx4 v2, s[24:27], s94 offen offset:3072 sc1 lds
  v_mfma_f32_16x16x32_bf16 v[208:211], v[168:171], v[72:75], v[208:211]
  ds_read_b128 v[168:171], v12 offset:52224
  v_mfma_f32_16x16x32_bf16 v[212:215], v[172:175], v[72:75], v[212:215]
  ds_read_b128 v[172:175], v12 offset:53248
  v_mfma_f32_16x16x32_bf16 v[216:219], v[176:179], v[72:75], v[216:219]
  ds_read_b128 v[176:179], v12 offset:54272
  s_add_u32 m0, s63, 45056
  s_add_u32 s94, s56, 106496
  buffer_load_dwordx4 v2, s[24:27], s94 offen offset:0 sc1 lds
  v_mfma_f32_16x16x32_bf16 v[220:223], v[180:183], v[72:75], v[220:223]
  ds_read_b128 v[180:183], v12 offset:55296
  s_waitcnt lgkmcnt(5)
  v_mfma_f32_16x16x32_bf16 v[204:207], v[184:187], v[76:79], v[204:207]
  ds_read_b128 v[184:187], v12 offset:56320
  v_mfma_f32_16x16x32_bf16 v[208:211], v[188:191], v[76:79], v[208:211]
  ds_read_b128 v[188:191], v12 offset:57344
  v_mfma_f32_16x16x32_bf16 v[212:215], v[192:195], v[76:79], v[212:215]
  ds_read_b128 v[192:195], v12 offset:58368
  v_mfma_f32_16x16x32_bf16 v[216:219], v[196:199], v[76:79], v[216:219]
  ds_read_b128 v[196:199], v12 offset:59392
  v_mfma_f32_16x16x32_bf16 v[220:223], v[200:203], v[76:79], v[220:223]
  ds_read_b128 v[200:203], v12 offset:60416
  s_waitcnt vmcnt(5)
  s_barrier
  s_waitcnt lgkmcnt(5)
  v_mfma_f32_16x16x32_bf16 v[204:207], v[164:167], v[80:83], v[204:207]
  ds_read_b128 v[164:167], v11 offset:0
  v_mfma_f32_16x16x32_bf16 v[208:211], v[168:171], v[80:83], v[208:211]
  ds_read_b128 v[168:171], v11 offset:1024
  v_mfma_f32_16x16x32_bf16 v[212:215], v[172:175], v[80:83], v[212:215]
  ds_read_b128 v[172:175], v11 offset:2048
  s_add_u32 m0, s63, 81920
  s_add_u32 s94, s56, 122880
  buffer_load_dwordx4 v2, s[24:27], s94 offen offset:0 sc1 lds
  v_mfma_f32_16x16x32_bf16 v[216:219], v[176:179], v[80:83], v[216:219]
  ds_read_b128 v[176:179], v11 offset:3072
  v_mfma_f32_16x16x32_bf16 v[220:223], v[180:183], v[80:83], v[220:223]
  ds_read_b128 v[180:183], v11 offset:4096
  s_waitcnt lgkmcnt(5)
  v_mfma_f32_16x16x32_bf16 v[204:207], v[184:187], v[84:87], v[204:207]
  ds_read_b128 v[184:187], v11 offset:5120
  buffer_load_dwordx4 v2, s[24:27], s94 offen offset:1024 sc1 lds
  v_mfma_f32_16x16x32_bf16 v[208:211], v[188:191], v[84:87], v[208:211]
  ds_read_b128 v[188:191], v11 offset:6144
  v_mfma_f32_16x16x32_bf16 v[212:215], v[192:195], v[84:87], v[212:215]
  ds_read_b128 v[192:195], v11 offset:7168
  v_mfma_f32_16x16x32_bf16 v[216:219], v[196:199], v[84:87], v[216:219]
  ds_read_b128 v[196:199], v11 offset:8192
  buffer_load_dwordx4 v2, s[24:27], s94 offen offset:2048 sc1 lds
  v_mfma_f32_16x16x32_bf16 v[220:223], v[200:203], v[84:87], v[220:223]
  ds_read_b128 v[200:203], v11 offset:9216
  s_waitcnt lgkmcnt(5)
  v_mfma_f32_16x16x32_bf16 v[204:207], v[164:167], v[88:91], v[204:207]
  ds_read_b128 v[164:167], v11 offset:10240
  v_mfma_f32_16x16x32_bf16 v[208:211], v[168:171], v[88:91], v[208:211]
  ds_read_b128 v[168:171], v11 offset:11264
  buffer_load_dwordx4 v2, s[24:27], s94 offen offset:3072 sc1 lds
  v_mfma_f32_16x16x32_bf16 v[212:215], v[172:175], v[88:91], v[212:215]
  ds_read_b128 v[172:175], v11 offset:12288
  v_mfma_f32_16x16x32_bf16 v[216:219], v[176:179], v[88:91], v[216:219]
  ds_read_b128 v[176:179], v11 offset:13312
  v_mfma_f32_16x16x32_bf16 v[220:223], v[180:183], v[88:91], v[220:223]
  ds_read_b128 v[180:183], v11 offset:14336
  s_add_u32 m0, s63, 86016
  s_add_u32 s94, s56, 126976
  buffer_load_dwordx4 v2, s[24:27], s94 offen offset:0 sc1 lds
  s_waitcnt lgkmcnt(5)
  v_mfma_f32_16x16x32_bf16 v[204:207], v[184:187], v[92:95], v[204:207]
  ds_read_b128 v[184:187], v11 offset:15360
  v_mfma_f32_16x16x32_bf16 v[208:211], v[188:191], v[92:95], v[208:211]
  ds_read_b128 v[188:191], v11 offset:16384
  v_mfma_f32_16x16x32_bf16 v[212:215], v[192:195], v[92:95], v[212:215]
  ds_read_b128 v[192:195], v11 offset:17408
  v_mfma_f32_16x16x32_bf16 v[216:219], v[196:199], v[92:95], v[216:219]
  ds_read_b128 v[196:199], v11 offset:18432
  v_mfma_f32_16x16x32_bf16 v[220:223], v[200:203], v[92:95], v[220:223]
  ds_read_b128 v[200:203], v11 offset:19456
  s_waitcnt vmcnt(5)
  s_barrier
  s_waitcnt lgkmcnt(5)
  v_mfma_f32_16x16x32_bf16 v[204:207], v[164:167], v[96:99], v[204:207]
  ds_read_b128 v[164:167], v11 offset:40960
  s_add_u32 m0, s63, 122880
  s_add_u32 s94, s56, 143360
  buffer_load_dwordx4 v2, s[24:27], s94 offen offset:0 sc1 lds
  v_mfma_f32_16x16x32_bf16 v[208:211], v[168:171], v[96:99], v[208:211]
  ds_read_b128 v[168:171], v11 offset:41984
  v_mfma_f32_16x16x32_bf16 v[212:215], v[172:175], v[96:99], v[212:215]
  ds_read_b128 v[172:175], v11 offset:43008
  v_mfma_f32_16x16x32_bf16 v[216:219], v[176:179], v[96:99], v[216:219]
  ds_read_b128 v[176:179], v11 offset:44032
  buffer_load_dwordx4 v2, s[24:27], s94 offen offset:1024 sc1 lds
  v_mfma_f32_16x16x32_bf16 v[220:223], v[180:183], v[96:99], v[220:223]
  ds_read_b128 v[180:183], v11 offset:45056
  s_waitcnt lgkmcnt(5)
  v_mfma_f32_16x16x32_bf16 v[204:207], v[184:187], v[100:103], v[204:207]
  ds_read_b128 v[184:187], v11 offset:46080
  v_mfma_f32_16x16x32_bf16 v[208:211], v[188:191], v[100:103], v[208:211]
  ds_read_b128 v[188:191], v11 offset:47104
  buffer_load_dwordx4 v2, s[24:27], s94 offen offset:2048 sc1 lds
  v_mfma_f32_16x16x32_bf16 v[212:215], v[192:195], v[100:103], v[212:215]
  ds_read_b128 v[192:195], v11 offset:48128
  v_mfma_f32_16x16x32_bf16 v[216:219], v[196:199], v[100:103], v[216:219]
  ds_read_b128 v[196:199], v11 offset:49152
  v_mfma_f32_16x16x32_bf16 v[220:223], v[200:203], v[100:103], v[220:223]
  ds_read_b128 v[200:203], v11 offset:50176
  buffer_load_dwordx4 v2, s[24:27], s94 offen offset:3072 sc1 lds
  s_waitcnt lgkmcnt(5)
  v_mfma_f32_16x16x32_bf16 v[204:207], v[164:167], v[104:107], v[204:207]
  ds_read_b128 v[164:167], v11 offset:51200
  v_mfma_f32_16x16x32_bf16 v[208:211], v[168:171], v[104:107], v[208:211]
  ds_read_b128 v[168:171], v11 offset:52224
  v_mfma_f32_16x16x32_bf16 v[212:215], v[172:175], v[104:107], v[212:215]
  ds_read_b128 v[172:175], v11 offset:53248
  s_add_u32 m0, s63, 126976
  s_add_u32 s94, s56, 147456
  buffer_load_dwordx4 v2, s[24:27], s94 offen offset:0 sc1 lds
  v_mfma_f32_16x16x32_bf16 v[216:219], v[176:179], v[104:107], v[216:219]
  ds_read_b128 v[176:179], v11 offset:54272
  v_mfma_f32_16x16x32_bf16 v[220:223], v[180:183], v[104:107], v[220:223]
  ds_read_b128 v[180:183], v11 offset:55296
  s_waitcnt lgkmcnt(5)
  v_mfma_f32_16x16x32_bf16 v[204:207], v[184:187], v[108:111], v[204:207]
  ds_read_b128 v[184:187], v11 offset:56320
  v_mfma_f32_16x16x32_bf16 v[208:211], v[188:191], v[108:111], v[208:211]
  ds_read_b128 v[188:191], v11 offset:57344
  v_mfma_f32_16x16x32_bf16 v[212:215], v[192:195], v[108:111], v[212:215]
  ds_read_b128 v[192:195], v11 offset:58368
  v_mfma_f32_16x16x32_bf16 v[216:219], v[196:199], v[108:111], v[216:219]
  ds_read_b128 v[196:199], v11 offset:59392
  v_mfma_f32_16x16x32_bf16 v[220:223], v[200:203], v[108:111], v[220:223]
  ds_read_b128 v[200:203], v11 offset:60416
  s_waitcnt vmcnt(5)
  s_barrier
  s_waitcnt lgkmcnt(5)
  v_mfma_f32_16x16x32_bf16 v[204:207], v[164:167], v[112:115], v[204:207]
  ds_read_b128 v[164:167], v12 offset:0
  v_mfma_f32_16x16x32_bf16 v[208:211], v[168:171], v[112:115], v[208:211]
  ds_read_b128 v[168:171], v12 offset:1024
  s_add_u32 m0, s63, 0
  s_add_u32 s94, s56, 163840
  buffer_load_dwordx4 v2, s[24:27], s94 offen offset:0 sc1 lds
  v_mfma_f32_16x16x32_bf16 v[212:215], v[172:175], v[112:115], v[212:215]
  ds_read_b128 v[172:175], v12 offset:2048
  v_mfma_f32_16x16x32_bf16 v[216:219], v[176:179], v[112:115], v[216:219]
  ds_read_b128 v[176:179], v12 offset:3072
  v_mfma_f32_16x16x32_bf16 v[220:223], v[180:183], v[112:115], v[220:223]
  ds_read_b128 v[180:183], v12 offset:4096
  buffer_load_dwordx4 v2, s[24:27], s94 offen offset:1024 sc1 lds
  s_cmp_lg_u32 s3, 0
  s_cbranch_scc1 L_o_nopoll
  buffer_load_dword v16, v10, s[24:27], s60 offen sc1
L_o_nopoll:
  s_waitcnt lgkmcnt(5)
  v_mfma_f32_16x16x32_bf16 v[204:207], v[184:187], v[116:119], v[204:207]
  ds_read_b128 v[184:187], v12 offset:5120
  v_mfma_f32_16x16x32_bf16 v[208:211], v[188:191], v[116:119], v[208:211]
  ds_read_b128 v[188:191], v12 offset:6144
  v_mfma_f32_16x16x32_bf16 v[212:215], v[192:195], v[116:119], v[212:215]
  ds_read_b128 v[192:195], v12 offset:7168
  buffer_load_dwordx4 v2, s[24:27], s94 offen offset:2048 sc1 lds
  v_mfma_f32_16x16x32_bf16 v[216:219], v[196:199], v[116:119], v[216:219]
  ds_read_b128 v[196:199], v12 offset:8192
  v_mfma_f32_16x16x32_bf16 v[220:223], v[200:203], v[116:119], v[220:223]
  ds_read_b128 v[200:203], v12 offset:9216
  s_waitcnt lgkmcnt(5)
  v_mfma_f32_16x16x32_bf16 v[204:207], v[164:167], v[120:123], v[204:207]
  ds_read_b128 v[164:167], v12 offset:10240
  buffer_load_dwordx4 v2, s[24:27], s94 offen offset:3072 sc1 lds
  v_lshlrev_b32 v32, 16, v20
  v_mfma_f32_16x16x32_bf16 v[208:211], v[168:171], v[120:123], v[208:211]
  ds_read_b128 v[168:171], v12 offset:11264
  v_and_b32 v33, 0xffff0000, v20
  v_mfma_f32_16x16x32_bf16 v[212:215], v[172:175], v[120:123], v[212:215]
  ds_read_b128 v[172:175], v12 offset:12288
  v_lshlrev_b32 v34, 16, v21
  v_mfma_f32_16x16x32_bf16 v[216:219], v[176:179], v[120:123], v[216:219]
  ds_read_b128 v[176:179], v12 offset:13312
  s_add_u32 m0, s63, 4096
  s_add_u32 s94, s56, 167936
  buffer_load_dwordx4 v2, s[24:27], s94 offen offset:0 sc1 lds
  v_and_b32 v35, 0xffff0000, v21
  v_mfma_f32_16x16x32_bf16 v[220:223], v[180:183], v[120:123], v[220:223]
  ds_read_b128 v[180:183], v12 offset:14336
  v_lshlrev_b32 v36, 16, v22
  s_waitcnt lgkmcnt(5)
  v_mfma_f32_16x16x32_bf16 v[204:207], v[184:187], v[124:127], v[204:207]
  ds_read_b128 v[184:187], v12 offset:15360
  v_and_b32 v37, 0xffff0000, v22
  v_mfma_f32_16x16x32_bf16 v[208:211], v[188:191], v[124:127], v[208:211]
  ds_read_b128 v[188:191], v12 offset:16384
  v_lshlrev_b32 v38, 16, v23
  v_mfma_f32_16x16x32_bf16 v[212:215], v[192:195], v[124:127], v[212:215]
  ds_read_b128 v[192:195], v12 offset:17408
  v_and_b32 v39, 0xffff0000, v23
  v_mfma_f32_16x16x32_bf16 v[216:219], v[196:199], v[124:127], v[216:219]
  ds_read_b128 v[196:199], v12 offset:18432
  v_lshlrev_b32 v40, 16, v15
  v_mfma_f32_16x16x32_bf16 v[220:223], v[200:203], v[124:127], v[220:223]
  ds_read_b128 v[200:203], v12 offset:19456
  v_and_b32 v41, 0xffff0000, v15
  s_cmp_lg_u32 s3, 0
  s_cbranch_scc1 L_sp_o_done
  s_waitcnt vmcnt(3)
  v_cmp_ne_u32 vcc, s36, v16
  s_cbranch_vccnz L_sp_o
L_sp_o_done:
  s_waitcnt vmcnt(5)
  s_barrier
  s_waitcnt lgkmcnt(5)
  v_mfma_f32_16x16x32_bf16 v[204:207], v[164:167], v[128:131], v[204:207]
  ds_read_b128 v[164:167], v12 offset:40960
  buffer_load_dwordx4 v[132:135], v13, s[24:27], s55 offen offset:0 sc1
  s_mov_b64 s[32:33], s[18:19]
  v_mfma_f32_16x16x32_bf16 v[208:211], v[168:171], v[128:131], v[208:211]
  ds_read_b128 v[168:171], v12 offset:41984
  v_mfma_f32_16x16x32_bf16 v[212:215], v[172:175], v[128:131], v[212:215]
  ds_read_b128 v[172:175], v12 offset:43008
  buffer_load_dwordx4 v[136:139], v13, s[24:27], s55 offen offset:2048 sc1
  v_mfma_f32_16x16x32_bf16 v[216:219], v[176:179], v[128:131], v[216:219]
  ds_read_b128 v[176:179], v12 offset:44032
  v_mfma_f32_16x16x32_bf16 v[220:223], v[180:183], v[128:131], v[220:223]
  ds_read_b128 v[180:183], v12 offset:45056
  s_add_u32 s55, s55, 4096
  buffer_load_dwordx4 v[140:143], v13, s[24:27], s55 offen offset:0 sc1
  buffer_load_dwordx4 v[144:147], v13, s[24:27], s55 offen offset:2048 sc1
  ds_write_b128 v14, v[204:207] offset:0
  s_add_u32 s55, s55, 4096
  buffer_load_dwordx4 v[148:151], v13, s[24:27], s55 offen offset:0 sc1
  ds_write_b128 v14, v[208:211] offset:64
  buffer_load_dwordx4 v[152:155], v13, s[24:27], s55 offen offset:2048 sc1
  ds_write_b128 v14, v[212:215] offset:128
  ds_write_b128 v14, v[216:219] offset:192
  ds_write_b128 v14, v[220:223] offset:256
  s_waitcnt vmcnt(6)
  s_waitcnt lgkmcnt(0)
  s_barrier
  ds_read_b128 v[52:55], v8 offset:0
  ds_read_b128 v[56:59], v8 offset:20480
  ds_read_b128 v[60:63], v8 offset:8192
  ds_read_b128 v[64:67], v8 offset:28672
  ds_read_b64 v[68:69], v9 offset:0
  ds_read_b64 v[72:73], v9 offset:20480
  s_waitcnt vmcnt(5)
  v_mfma_f32_16x16x32_bf16 v[224:227], v[184:187], v[132:135], 0
  ds_read_b128 v[184:187], v12 offset:46080
  v_mfma_f32_16x16x32_bf16 v[228:231], v[188:191], v[132:135], 0
  ds_read_b128 v[188:191], v12 offset:47104
  s_add_u32 s55, s55, 4096
  buffer_load_dwordx4 v[156:159], v13, s[24:27], s55 offen offset:0 sc1
  v_mfma_f32_16x16x32_bf16 v[232:235], v[192:195], v[132:135], 0
  ds_read_b128 v[192:195], v12 offset:48128
  v_mfma_f32_16x16x32_bf16 v[236:239], v[196:199], v[132:135], 0
  ds_read_b128 v[196:199], v12 offset:49152
  buffer_load_dwordx4 v[160:163], v13, s[24:27], s55 offen offset:2048 sc1
  v_mfma_f32_16x16x32_bf16 v[240:243], v[200:203], v[132:135], 0
  ds_read_b128 v[200:203], v12 offset:50176
  s_waitcnt vmcnt(6)
  v_mfma_f32_16x16x32_bf16 v[224:227], v[164:167], v[136:139], v[224:227]
  ds_read_b128 v[164:167], v12 offset:51200
  s_add_u32 s55, s55, 4096
  buffer_load_dwordx4 v[244:247], v13, s[24:27], s55 offen offset:0 sc1
  s_waitcnt lgkmcnt(6)
  s_mov_b32 s53, 0xbfb8aa3b
  v_add_u32 v8, 81920, v8
  v_mfma_f32_16x16x32_bf16 v[228:231], v[168:171], v[136:139], v[228:231]
  ds_read_b128 v[168:171], v12 offset:52224
  v_add_u32 v9, 81920, v9
  v_add_u32 v14, 81920, v14
  v_mfma_f32_16x16x32_bf16 v[232:235], v[172:175], v[136:139], v[232:235]
  ds_read_b128 v[172:175], v12 offset:53248
  buffer_load_dwordx4 v[248:251], v13, s[24:27], s55 offen offset:2048 sc1
  v_add_f32 v76, v52, v56
  v_add_f32 v77, v53, v57
  v_mfma_f32_16x16x32_bf16 v[236:239], v[176:179], v[136:139], v[236:239]
  ds_read_b128 v[176:179], v12 offset:54272
  v_add_f32 v78, v54, v58
  v_add_f32 v79, v55, v59
  v_mfma_f32_16x16x32_bf16 v[240:243], v[180:183], v[136:139], v[240:243]
  ds_read_b128 v[180:183], v12 offset:55296
  v_add_f32 v80, v60, v64
  v_add_f32 v81, v61, v65
  s_waitcnt vmcnt(7)
  s_waitcnt lgkmcnt(5)
  v_mfma_f32_16x16x32_bf16 v[224:227], v[184:187], v[140:143], v[224:227]
  ds_read_b128 v[184:187], v12 offset:56320
  v_add_f32 v82, v62, v66
  v_add_f32 v83, v63, v67
  v_mfma_f32_16x16x32_bf16 v[228:231], v[188:191], v[140:143], v[228:231]
  ds_read_b128 v[188:191], v12 offset:57344
  v_add_f32 v84, v68, v72
  v_add_f32 v85, v69, v73
  v_mfma_f32_16x16x32_bf16 v[232:235], v[192:195], v[140:143], v[232:235]
  ds_read_b128 v[192:195], v12 offset:58368
  v_mul_f32 v52, s53, v76
  v_mul_f32 v53, s53, v77
  v_mfma_f32_16x16x32_bf16 v[236:239], v[196:199], v[140:143], v[236:239]
  ds_read_b128 v[196:199], v12 offset:59392
  v_mul_f32 v54, s53, v78
  v_mul_f32 v55, s53, v79
  v_mfma_f32_16x16x32_bf16 v[240:243], v[200:203], v[140:143], v[240:243]
  ds_read_b128 v[200:203], v12 offset:60416
  v_mul_f32 v56, s53, v80
  v_mul_f32 v57, s53, v81
  s_waitcnt vmcnt(6)
  s_waitcnt lgkmcnt(5)
  v_mfma_f32_16x16x32_bf16 v[224:227], v[164:167], v[144:147], v[224:227]
  ds_read_b128 v[164:167], v11 offset:0
  s_mul_i32 s37, s39, 4096
  s_sub_u32 s94, s56, s37
  s_add_u32 s94, s94, 184320
  s_sub_u32 s37, s63, s37
  s_add_u32 m0, s37, 81920
  s_lshl_b32 s38, s39, 10
  buffer_load_dwordx4 v2, s[24:27], s94 offen sc1 lds
  v_mul_f32 v58, s53, v82
  v_mul_f32 v59, s53, v83
  v_mfma_f32_16x16x32_bf16 v[228:231], v[168:171], v[144:147], v[228:231]
  ds_read_b128 v[168:171], v11 offset:1024
  v_mul_f32 v60, s53, v84
  v_mul_f32 v61, s53, v85
  v_mfma_f32_16x16x32_bf16 v[232:235], v[172:175], v[144:147], v[232:235]
  ds_read_b128 v[172:175], v11 offset:2048
  v_exp_f32 v52, v52
  v_mfma_f32_16x16x32_bf16 v[236:239], v[176:179], v[144:147], v[236:239]
  ds_read_b128 v[176:179], v11 offset:3072
  s_sub_u32 s38, 4096, s38
  s_add_u32 m0, m0, s38
  s_add_u32 s94, s94, s38
  buffer_load_dwordx4 v2, s[24:27], s94 offen sc1 lds
  v_exp_f32 v53, v53
  v_mfma_f32_16x16x32_bf16 v[240:243], v[180:183], v[144:147], v[240:243]
  ds_read_b128 v[180:183], v11 offset:4096
  v_exp_f32 v54, v54
  s_waitcnt vmcnt(7)
  s_waitcnt lgkmcnt(5)
  v_mfma_f32_16x16x32_bf16 v[224:227], v[184:187], v[148:151], v[224:227]
  ds_read_b128 v[184:187], v11 offset:5120
  v_exp_f32 v55, v55
  v_mfma_f32_16x16x32_bf16 v[228:231], v[188:191], v[148:151], v[228:231]
  ds_read_b128 v[188:191], v11 offset:6144
  v_exp_f32 v56, v56
  v_mfma_f32_16x16x32_bf16 v[232:235], v[192:195], v[148:151], v[232:235]
  ds_read_b128 v[192:195], v11 offset:7168
  v_exp_f32 v57, v57
  v_mfma_f32_16x16x32_bf16 v[236:239], v[196:199], v[148:151], v[236:239]
  ds_read_b128 v[196:199], v11 offset:8192
  v_exp_f32 v58, v58
  v_mfma_f32_16x16x32_bf16 v[240:243], v[200:203], v[148:151], v[240:243]
  ds_read_b128 v[200:203], v11 offset:9216
  v_exp_f32 v59, v59
  s_waitcnt vmcnt(6)
  s_waitcnt lgkmcnt(5)
  v_mfma_f32_16x16x32_bf16 v[224:227], v[164:167], v[152:155], v[224:227]
  ds_read_b128 v[164:167], v11 offset:10240
  v_exp_f32 v60, v60
  v_mfma_f32_16x16x32_bf16 v[228:231], v[168:171], v[152:155], v[228:231]
  ds_read_b128 v[168:171], v11 offset:11264
  v_exp_f32 v61, v61
  v_mfma_f32_16x16x32_bf16 v[232:235], v[172:175], v[152:155], v[232:235]
  ds_read_b128 v[172:175], v11 offset:12288
  v_add_f32 v52, 1.0, v52
  v_add_f32 v53, 1.0, v53
  v_mfma_f32_16x16x32_bf16 v[236:239], v[176:179], v[152:155], v[236:239]
  ds_read_b128 v[176:179], v11 offset:13312
  v_add_f32 v54, 1.0, v54
  v_add_f32 v55, 1.0, v55
  v_mfma_f32_16x16x32_bf16 v[240:243], v[180:183], v[152:155], v[240:243]
  ds_read_b128 v[180:183], v11 offset:14336
  v_add_f32 v56, 1.0, v56
  v_add_f32 v57, 1.0, v57
  s_waitcnt vmcnt(5)
  s_waitcnt lgkmcnt(5)
  v_mfma_f32_16x16x32_bf16 v[224:227], v[184:187], v[156:159], v[224:227]
  ds_read_b128 v[184:187], v11 offset:15360
  v_add_f32 v58, 1.0, v58
  v_add_f32 v59, 1.0, v59
  v_mfma_f32_16x16x32_bf16 v[228:231], v[188:191], v[156:159], v[228:231]
  ds_read_b128 v[188:191], v11 offset:16384
  v_add_f32 v60, 1.0, v60
  v_add_f32 v61, 1.0, v61
  v_mfma_f32_16x16x32_bf16 v[232:235], v[192:195], v[156:159], v[232:235]
  ds_read_b128 v[192:195], v11 offset:17408
  v_rcp_f32 v52, v52
  v_mfma_f32_16x16x32_bf16 v[236:239], v[196:199], v[156:159], v[236:239]
  ds_read_b128 v[196:199], v11 offset:18432
  v_rcp_f32 v53, v53
  v_mfma_f32_16x16x32_bf16 v[240:243], v[200:203], v[156:159], v[240:243]
  ds_read_b128 v[200:203], v11 offset:19456
  v_rcp_f32 v54, v54
  s_waitcnt vmcnt(0)
  s_barrier
  s_waitcnt lgkmcnt(5)
  v_mfma_f32_16x16x32_bf16 v[224:227], v[164:167], v[160:163], v[224:227]
  ds_read_b128 v[164:167], v12 offset:0
  v_rcp_f32 v55, v55
  v_mfma_f32_16x16x32_bf16 v[228:231], v[168:171], v[160:163], v[228:231]
  ds_read_b128 v[168:171], v12 offset:1024
  v_rcp_f32 v56, v56
  v_mfma_f32_16x16x32_bf16 v[232:235], v[172:175], v[160:163], v[232:235]
  ds_read_b128 v[172:175], v12 offset:2048
  v_rcp_f32 v57, v57
  v_mfma_f32_16x16x32_bf16 v[236:239], v[176:179], v[160:163], v[236:239]
  ds_read_b128 v[176:179], v12 offset:3072
  v_rcp_f32 v58, v58
  v_mfma_f32_16x16x32_bf16 v[240:243], v[180:183], v[160:163], v[240:243]
  ds_read_b128 v[180:183], v12 offset:4096
  v_rcp_f32 v59, v59
  s_waitcnt lgkmcnt(9)
  v_mfma_f32_16x16x32_bf16 v[224:227], v[184:187], v[244:247], v[224:227]
  v_rcp_f32 v60, v60
  s_waitcnt lgkmcnt(4)
  v_mfma_f32_16x16x32_bf16 v[224:227], v[164:167], v[248:251], v[224:227]
  v_rcp_f32 v61, v61
  v_mfma_f32_16x16x32_bf16 v[228:231], v[188:191], v[244:247], v[228:231]
  v_mul_f32 v76, v76, v52
  v_mul_f32 v77, v77, v53
  s_waitcnt lgkmcnt(3)
  v_mfma_f32_16x16x32_bf16 v[228:231], v[168:171], v[248:251], v[228:231]
  s_nop 1
  ds_write_b128 v14, v[224:227] offset:0
  v_mul_f32 v78, v78, v54
  v_mul_f32 v79, v79, v55
  v_mfma_f32_16x16x32_bf16 v[232:235], v[192:195], v[244:247], v[232:235]
  v_mul_f32 v80, v80, v56
  v_mul_f32 v81, v81, v57
  s_waitcnt lgkmcnt(3)
  v_mfma_f32_16x16x32_bf16 v[232:235], v[172:175], v[248:251], v[232:235]
  ds_write_b128 v14, v[228:231] offset:64
  v_mul_f32 v82, v82, v58
  v_mul_f32 v83, v83, v59
  v_mfma_f32_16x16x32_bf16 v[236:239], v[196:199], v[244:247], v[236:239]
  v_mul_f32 v84, v84, v60
  v_mul_f32 v85, v85, v61
  s_waitcnt lgkmcnt(3)
  v_mfma_f32_16x16x32_bf16 v[236:239], v[176:179], v[248:251], v[236:239]
  ds_write_b128 v14, v[232:235] offset:128
  v_mfma_f32_16x16x32_bf16 v[240:243], v[200:203], v[244:247], v[240:243]
  s_waitcnt lgkmcnt(3)
  v_mfma_f32_16x16x32_bf16 v[240:243], v[180:183], v[248:251], v[240:243]
  s_nop 3
  ds_write_b128 v14, v[236:239] offset:192
  s_nop 2
  ds_write_b128 v14, v[240:243] offset:256
  s_waitcnt lgkmcnt(0)
  s_barrier
  ds_read_b128 v[52:55], v8 offset:0
  ds_read_b128 v[56:59], v8 offset:20480
  ds_read_b128 v[60:63], v8 offset:8192
  ds_read_b128 v[64:67], v8 offset:28672
  ds_read_b64 v[68:69], v9 offset:0
  ds_read_b64 v[72:73], v9 offset:20480
  s_waitcnt lgkmcnt(4)
  v_pk_add_f32 v[52:53], v[52:53], v[56:57]
  v_pk_add_f32 v[54:55], v[54:55], v[58:59]
  v_pk_fma_f32 v[32:33], v[52:53], v[76:77], v[32:33]
  v_pk_fma_f32 v[34:35], v[54:55], v[78:79], v[34:35]
  v_cvt_pk_bf16_f32 v24, v32, v33
  v_cvt_pk_bf16_f32 v25, v34, v35
  buffer_store_dwordx2 v[24:25], v253, s[32:35], s57 offen
  s_waitcnt lgkmcnt(2)
  v_pk_add_f32 v[60:61], v[60:61], v[64:65]
  v_pk_add_f32 v[62:63], v[62:63], v[66:67]
  v_pk_fma_f32 v[36:37], v[60:61], v[80:81], v[36:37]
  v_pk_fma_f32 v[38:39], v[62:63], v[82:83], v[38:39]
  v_cvt_pk_bf16_f32 v26, v36, v37
  v_cvt_pk_bf16_f32 v27, v38, v39
  buffer_store_dwordx2 v[26:27], v254, s[32:35], s57 offen
  s_waitcnt lgkmcnt(0)
  v_pk_add_f32 v[68:69], v[68:69], v[72:73]
  v_pk_fma_f32 v[40:41], v[68:69], v[84:85], v[40:41]
  v_cvt_pk_bf16_f32 v28, v40, v41
  buffer_store_dword v28, v255, s[32:35], s57 offen
L_end:
  s_endpgm
L_sp_o:
  s_mov_b32 s41, 65536
L_sp_o_loop:
  buffer_load_dword v16, v10, s[24:27], s60 offen sc1
  s_waitcnt vmcnt(0)
  v_cmp_ne_u32 vcc, s36, v16
  s_cbranch_vccz L_sp_o_done
  s_sleep 4
  s_sub_u32 s41, s41, 1
  s_cmp_lg_u32 s41, 0
  s_cbranch_scc1 L_sp_o_loop
  s_branch L_sp_o_done
L_sp_ln:
  s_mov_b32 s41, 65536
L_sp_ln_loop:
  buffer_load_dwordx2 v[216:217], v238, s[24:27], s81 offen sc1
  s_waitcnt vmcnt(0)
  v_cmp_ne_u32 vcc, s36, v217
  s_cbranch_vccz L_sp_ln_done
  s_sleep 8
  s_sub_u32 s41, s41, 1
  s_cmp_lg_u32 s41, 0
  s_cbranch_scc1 L_sp_ln_loop
  s_branch L_sp_ln_done
L_sp_st:
  s_mov_b32 s41, 65536
L_sp_st_loop:
  buffer_load_dwordx4 v[224:227], v239, s[24:27], s83 offen offset:0 sc1
  buffer_load_dwordx4 v[228:231], v239, s[24:27], s83 offen offset:256 sc1
  s_waitcnt vmcnt(0)
  v_xor_b32 v225, s36, v225
  v_bitop3_b32 v225, v225, v227, s36 bitop3:0xf6
  v_bitop3_b32 v225, v225, v229, s36 bitop3:0xf6
  v_bitop3_b32 v225, v225, v231, s36 bitop3:0xf6
  v_cmp_ne_u32 vcc, 0, v225
  s_cbranch_vccz L_sp_st_done
  s_sleep 8
  s_sub_u32 s41, s41, 1
  s_cmp_lg_u32 s41, 0
  s_cbranch_scc1 L_sp_st_loop
  s_branch L_sp_st_done
L_sp_g:
  s_mov_b32 s41, 65536
L_sp_g_loop:
  buffer_load_dwordx4 v[224:227], v239, s[24:27], s84 offen offset:0 sc1
  buffer_load_dwordx4 v[228:231], v239, s[24:27], s84 offen offset:256 sc1
  s_waitcnt vmcnt(0)
  v_xor_b32 v225, s36, v225
  v_bitop3_b32 v225, v225, v227, s36 bitop3:0xf6
  v_bitop3_b32 v225, v225, v229, s36 bitop3:0xf6
  v_bitop3_b32 v225, v225, v231, s36 bitop3:0xf6
  v_cmp_ne_u32 vcc, 0, v225
  s_cbranch_vccz L_sp_g_done
  s_sleep 8
  s_sub_u32 s41, s41, 1
  s_cmp_lg_u32 s41, 0
  s_cbranch_scc1 L_sp_g_loop
  s_branch L_sp_g_done
L_sp_u:
  s_mov_b32 s41, 65536
L_sp_u_loop:
  buffer_load_dwordx4 v[224:227], v239, s[24:27], s85 offen offset:0 sc1
  buffer_load_dwordx4 v[228:231], v239, s[24:27], s85 offen offset:256 sc1
  s_waitcnt vmcnt(0)
  v_xor_b32 v225, s36, v225
  v_bitop3_b32 v225, v225, v227, s36 bitop3:0xf6
  v_bitop3_b32 v225, v225, v229, s36 bitop3:0xf6
  v_bitop3_b32 v225, v225, v231, s36 bitop3:0xf6
  v_cmp_ne_u32 vcc, 0, v225
  s_cbranch_vccz L_sp_u_done
  s_sleep 8
  s_sub_u32 s41, s41, 1
  s_cmp_lg_u32 s41, 0
  s_cbranch_scc1 L_sp_u_loop
  s_branch L_sp_u_done
L_role_r:
  s_sub_u32 s37, s65, 30
  s_lshl3_add_u32 s37, s37, s64
  s_lshl3_add_u32 s37, s37, s3
  s_mov_b32 s30, 2211840
  s_mov_b32 s67, 221184
  s_cmp_lt_u32 s37, 86
  s_cselect_b64 s[28:29], s[12:13], s[14:15]
  s_cselect_b32 s38, 45, 86
  s_cmp_lt_u32 s37, 45
  s_cselect_b64 s[28:29], s[6:7], s[28:29]
  s_cselect_b32 s30, 2457600, s30
  s_cselect_b32 s67, 245760, s67
  s_cselect_b32 s38, 0, s38
  s_sub_u32 s37, s37, s38
  s_mul_i32 s79, s37, 5504
  s_mul_i32 s37, s67, 3
  s_add_u32 s79, s79, s37
  v_lshlrev_b32 v248, 7, v1
  s_mov_b32 exec_hi, 0x7ff
  buffer_load_dword v200, v248, s[28:31], s79 offen
  s_mov_b32 exec_hi, -1
  s_add_u32 s79, s79, s67
  s_mov_b32 exec_hi, 0x7ff
  buffer_load_dword v200, v248, s[28:31], s79 offen
  s_mov_b32 exec_hi, -1
  s_add_u32 s79, s79, s67
  s_waitcnt vmcnt(2)
  v_lshlrev_b32 v222, 16, v216
  v_and_b32 v223, 0xffff0000, v216
  v_lshlrev_b32 v224, 16, v217
  v_and_b32 v225, 0xffff0000, v217
  v_lshlrev_b32 v226, 16, v218
  v_and_b32 v227, 0xffff0000, v218
  v_lshlrev_b32 v228, 16, v219
  v_and_b32 v229, 0xffff0000, v219
  v_lshlrev_b32 v230, 16, v220
  v_and_b32 v231, 0xffff0000, v220
  v_add_f32 v16, v222, v223
  v_add_f32 v16, v16, v224
  v_add_f32 v16, v16, v225
  v_add_f32 v16, v16, v226
  v_add_f32 v16, v16, v227
  v_add_f32 v16, v16, v228
  v_add_f32 v16, v16, v229
  v_add_f32 v16, v16, v230
  v_add_f32 v16, v16, v231
  s_nop 1
  v_add_f32_dpp v16, v16, v16 quad_perm:[1,0,3,2] row_mask:0xf bank_mask:0xf
  s_nop 1
  v_add_f32_dpp v16, v16, v16 quad_perm:[2,3,0,1] row_mask:0xf bank_mask:0xf
  s_nop 1
  v_add_f32_dpp v16, v16, v16 row_half_mirror row_mask:0xf bank_mask:0xf
  s_nop 1
  v_add_f32_dpp v16, v16, v16 row_mirror row_mask:0xf bank_mask:0xf
  s_nop 1
  v_add_f32_dpp v16, v16, v16 row_bcast:15 row_mask:0xa bank_mask:0xf
  s_nop 1
  v_add_f32_dpp v16, v16, v16 row_bcast:31 row_mask:0xc bank_mask:0xf
  v_mul_f32 v16, 0x3acccccd, v16
  s_nop 0
  v_readlane_b32 s37, v16, 63
  s_nop 1
  v_subrev_f32 v222, s37, v222
  v_subrev_f32 v223, s37, v223
  v_subrev_f32 v224, s37, v224
  v_subrev_f32 v225, s37, v225
  v_subrev_f32 v226, s37, v226
  v_subrev_f32 v227, s37, v227
  v_subrev_f32 v228, s37, v228
  v_subrev_f32 v229, s37, v229
  v_subrev_f32 v230, s37, v230
  v_subrev_f32 v231, s37, v231
  v_mul_f32 v17, v222, v222
  v_fmac_f32 v17, v223, v223
  v_fmac_f32 v17, v224, v224
  v_fmac_f32 v17, v225, v225
  v_fmac_f32 v17, v226, v226
  v_fmac_f32 v17, v227, v227
  v_fmac_f32 v17, v228, v228
  v_fmac_f32 v17, v229, v229
  v_fmac_f32 v17, v230, v230
  v_fmac_f32 v17, v231, v231
  s_waitcnt lgkmcnt(0)
  s_mul_i32 s36, s36, 0x9e3779b1
  s_add_u32 s36, s36, 0x7f4a7c15
  v_mov_b32 v3, s36
  v_add_f32_dpp v17, v17, v17 quad_perm:[1,0,3,2] row_mask:0xf bank_mask:0xf
  s_nop 1
  v_add_f32_dpp v17, v17, v17 quad_perm:[2,3,0,1] row_mask:0xf bank_mask:0xf
  s_nop 1
  v_add_f32_dpp v17, v17, v17 row_half_mirror row_mask:0xf bank_mask:0xf
  s_nop 1
  v_add_f32_dpp v17, v17, v17 row_mirror row_mask:0xf bank_mask:0xf
  s_nop 1
  v_add_f32_dpp v17, v17, v17 row_bcast:15 row_mask:0xa bank_mask:0xf
  s_nop 1
  v_add_f32_dpp v17, v17, v17 row_bcast:31 row_mask:0xc bank_mask:0xf
  v_mul_f32 v17, 0x3acccccd, v17
  v_cvt_pk_bf16_f32 v17, v17, v17
  v_and_b32 v17, 0xffff0000, v17
  v_add_f32 v17, 0x3727c5ac, v17
  v_cvt_pk_bf16_f32 v17, v17, v17
  v_and_b32 v17, 0xffff0000, v17
  v_sqrt_f32 v17, v17
  v_mov_b32 v19, v3
  v_cvt_pk_bf16_f32 v18, -v16, v17
  s_lshl_b32 s37, s82, 3
  s_add_u32 s37, s37, 20594688
  s_mov_b32 exec_lo, 0
  s_brev_b32 exec_hi, 1
  buffer_store_dwordx2 v[18:19], off, s[24:27], s37 sc1
  s_mov_b64 exec, -1
  s_mov_b32 exec_hi, 0x7ff
  buffer_load_dword v200, v248, s[28:31], s79 offen
  s_mov_b32 exec_hi, -1
  s_add_u32 s79, s79, s67
  s_lshl_b32 s37, s3, 2
  v_add_u32 v16, 0, v1
  v_mul_u32_u24 v17, 820, v16
  v_lshrrev_b32 v17, 16, v17
  v_mul_u32_u24 v18, 80, v17
  v_sub_u32 v18, v16, v18
  v_add_u32 v19, s37, v17
  v_lshrrev_b32 v20, 1, v19
  v_and_b32 v20, 4, v20
  v_or_b32 v20, v20, v17
  v_lshlrev_b32 v20, 1, v20
  v_xor_b32 v18, v18, v20
  v_mul_u32_u24 v19, 1280, v19
  v_lshl_add_u32 v80, v18, 4, v19
  v_add_u32 v16, 64, v1
  v_mul_u32_u24 v17, 820, v16
  v_lshrrev_b32 v17, 16, v17
  v_mul_u32_u24 v18, 80, v17
  v_sub_u32 v18, v16, v18
  v_add_u32 v19, s37, v17
  v_lshrrev_b32 v20, 1, v19
  v_and_b32 v20, 4, v20
  v_or_b32 v20, v20, v17
  v_lshlrev_b32 v20, 1, v20
  v_xor_b32 v18, v18, v20
  v_mul_u32_u24 v19, 1280, v19
  v_lshl_add_u32 v81, v18, 4, v19
  v_add_u32 v16, 128, v1
  v_mul_u32_u24 v17, 820, v16
  v_lshrrev_b32 v17, 16, v17
  v_mul_u32_u24 v18, 80, v17
  v_sub_u32 v18, v16, v18
  v_add_u32 v19, s37, v17
  v_lshrrev_b32 v20, 1, v19
  v_and_b32 v20, 4, v20
  v_or_b32 v20, v20, v17
  v_lshlrev_b32 v20, 1, v20
  v_xor_b32 v18, v18, v20
  v_mul_u32_u24 v19, 1280, v19
  v_lshl_add_u32 v82, v18, 4, v19
  v_add_u32 v16, 192, v1
  v_mul_u32_u24 v17, 820, v16
  v_lshrrev_b32 v17, 16, v17
  v_mul_u32_u24 v18, 80, v17
  v_sub_u32 v18, v16, v18
  v_add_u32 v19, s37, v17
  v_lshrrev_b32 v20, 1, v19
  v_and_b32 v20, 4, v20
  v_or_b32 v20, v20, v17
  v_lshlrev_b32 v20, 1, v20
  v_xor_b32 v18, v18, v20
  v_mul_u32_u24 v19, 1280, v19
  v_lshl_add_u32 v83, v18, 4, v19
  v_add_u32 v16, 256, v1
  v_mul_u32_u24 v17, 820, v16
  v_lshrrev_b32 v17, 16, v17
  v_mul_u32_u24 v18, 80, v17
  v_sub_u32 v18, v16, v18
  v_add_u32 v19, s37, v17
  v_lshrrev_b32 v20, 1, v19
  v_and_b32 v20, 4, v20
  v_or_b32 v20, v20, v17
  v_lshlrev_b32 v20, 1, v20
  v_xor_b32 v18, v18, v20
  v_mul_u32_u24 v19, 1280, v19
  v_lshl_add_u32 v84, v18, 4, v19
  v_lshrrev_b32 v16, 4, v1
  v_bfe_u32 v17, v1, 2, 2
  v_lshl_add_u32 v18, v16, 3, v17
  v_mul_u32_u24 v18, 1280, v18
  v_and_b32 v19, 1, v1
  v_lshl_add_u32 v18, v19, 3, v18
  v_and_b32 v16, 1, v16
  v_lshl_add_u32 v16, v16, 2, v17
  v_lshlrev_b32 v16, 1, v16
  v_bfe_u32 v17, v1, 1, 1
  s_mul_i32 s37, s3, 10
  v_add_u32 v17, s37, v17
  v_add_u32 v19, 0, v17
  v_xor_b32 v19, v19, v16
  v_lshl_add_u32 v85, v19, 4, v18
  v_add_u32 v19, 2, v17
  v_xor_b32 v19, v19, v16
  v_lshl_add_u32 v86, v19, 4, v18
  v_add_u32 v19, 4, v17
  v_xor_b32 v19, v19, v16
  v_lshl_add_u32 v87, v19, 4, v18
  v_add_u32 v19, 6, v17
  v_xor_b32 v19, v19, v16
  v_lshl_add_u32 v88, v19, 4, v18
  v_add_u32 v19, 8, v17
  v_xor_b32 v19, v19, v16
  v_lshl_add_u32 v89, v19, 4, v18
  s_sub_u32 s81, s65, 30
  s_lshl_b32 s81, s81, 3
  s_add_u32 s81, s81, s64
  s_mul_i32 s84, s3, 5120
  s_mov_b32 s28, s16
  s_mov_b32 s29, s17
  s_mov_b32 s30, 2211840
  s_add_u32 s37, s81, 0
  s_mul_i32 s82, s37, 40960
  s_add_u32 m0, s84, 0
  s_nop 0
  buffer_load_dwordx4 v80, s[28:31], s82 offen nt lds
  s_add_u32 m0, s84, 1024
  s_nop 0
  buffer_load_dwordx4 v81, s[28:31], s82 offen nt lds
  s_add_u32 m0, s84, 2048
  s_nop 0
  buffer_load_dwordx4 v82, s[28:31], s82 offen nt lds
  s_add_u32 m0, s84, 3072
  s_nop 0
  buffer_load_dwordx4 v83, s[28:31], s82 offen nt lds
  s_add_u32 m0, s84, 4096
  s_nop 0
  buffer_load_dwordx4 v84, s[28:31], s82 offen nt lds
  s_and_b32 s70, s2, 7
  s_lshr_b32 s69, s2, 6
  s_lshl2_add_u32 s70, s70, s69
  s_and_b32 s74, s70, 1
  s_mul_i32 s69, s70, 5
  s_lshr_b32 s69, s69, 1
  s_add_u32 s71, s69, s74
  s_add_u32 s66, s69, 2
  s_sub_u32 s73, s66, s74
  s_sub_u32 s73, s73, s74
  s_lshl_b32 s71, s71, 9
  s_lshl_b32 s73, s73, 9
  s_lshl_b32 s74, s74, 3
  s_lshr_b32 s69, s69, 2
  s_lshr_b32 s66, s66, 2
  s_sub_u32 s66, s66, s69
  v_lshrrev_b32 v244, 5, v1
  v_and_b32 v245, 31, v1
  v_and_b32 v246, s66, v244
  v_add_lshl_u32 v246, s69, v246, 10
  v_lshl_add_u32 v12, v245, 5, v246
  v_lshlrev_b32 v245, 4, v245
  s_mov_b32 s69, 122880
  v_mad_u32_u24 v10, v244, s69, v245
  s_xor_b32 s66, s40, 1
  v_xor_b32 v11, s66, v244
  v_mad_u32_u24 v11, v11, s69, v245
  s_lshr_b32 s69, s39, 1
  s_and_b32 s66, s39, 1
  s_mul_i32 s45, s69, 6336
  s_mul_i32 s42, s40, 12800
  s_add_u32 s45, s45, s42
  s_lshl_b32 s42, s66, 10
  s_add_u32 s45, s45, s42
  s_lshl4_add_u32 s66, s40, s66
  s_mul_i32 s66, s66, 6
  s_add_u32 s66, s66, s69
  s_add_u32 s66, s66, 1
  s_mul_i32 s66, s66, 40960
  s_add_u32 s42, s66, s71
  s_add_u32 s43, s66, s73
  s_bfe_u32 s66, s2, 0x30003
  s_lshl2_add_u32 s66, s66, s39
  s_add_u32 s73, s73, s74
  s_mul_i32 s50, s66, 245760
  s_add_u32 s50, s50, s73
  s_lshl1_add_u32 s66, s66, s40
  s_xor_b32 s69, s66, 1
  s_mul_i32 s48, s66, 122880
  s_mul_i32 s49, s69, 122880
  s_add_u32 s48, s48, s71
  s_add_u32 s49, s49, s71
  s_mul_i32 s37, s40, 12800
  s_add_u32 s37, s37, 81920
  v_lshrrev_b32 v244, 5, v1
  v_and_b32 v245, 0x1f0, v2
  v_mul_u32_u24 v5, 2112, v244
  v_add3_u32 v5, v5, v245, s37
  s_add_u32 s38, s74, s37
  s_add_u32 s38, s38, 4224
  v_add_u32 v6, s38, v245
  v_bfe_u32 v245, v1, 2, 2
  v_lshl_add_u32 v245, v244, 3, v245
  v_and_b32 v246, 1, v1
  v_mul_u32_u24 v246, 2112, v246
  v_bfe_u32 v247, v1, 1, 1
  v_lshlrev_b32 v247, 3, v247
  s_add_u32 s37, s37, 6336
  v_add3_u32 v246, v247, v246, s37
  s_add_u32 s38, s38, 6336
  v_mov_b32 v249, s38
  v_and_b32 v248, 19, v1
  v_cmp_eq_u32 vcc, 16, v248
  v_add_u32 v247, 158848, v247
  v_mov_b32 v4, 0xdddddddd
  v_cndmask_b32 v246, v246, v249, vcc
  v_cmp_lt_u32 vcc, 16, v248
  s_nop 1
  v_cndmask_b32 v246, v246, v247, vcc
  v_cndmask_b32 v8, 1, 0, vcc
  v_lshl_add_u32 v7, v245, 4, v246
  s_lshl1_add_u32 s61, s65, s40
  s_cmp_lt_u32 s65, 27
  s_cselect_b32 s61, s61, 63
  s_lshr_b32 s69, s2, 6
  s_xor_b32 s69, s69, s39
  s_lshl2_add_u32 s69, s64, s69
  s_lshl_b32 s69, s69, 8
  s_lshl2_add_u32 s61, s61, s69
  s_add_u32 s61, s61, 21241856
  s_mul_i32 s69, s66, 40960
  s_add_u32 s69, s69, 14942208
  s_add_u32 s52, s69, s73
  s_add_u32 s51, s69, s71
  s_lshl_b32 s53, s66, 5
  s_add_u32 s53, s53, s70
  s_lshl_b32 s53, s53, 2
  s_add_u32 s53, s53, 21254144
  s_bfe_u32 s71, s2, 0x20001
  s_bfe_u32 s69, s2, 0x30003
  s_lshl3_add_u32 s71, s71, s69
  s_and_b32 s73, s2, 1
  s_lshr_b32 s69, s2, 6
  s_lshl2_add_u32 s73, s73, s69
  s_lshl1_add_u32 s69, s73, s40
  s_lshl_b32 s59, s69, 8
  s_add_u32 s59, s59, 21250048
  s_mul_i32 s69, s69, 37
  s_add_u32 s69, s69, s39
  s_mul_i32 s56, s69, 5120
  s_add_u32 s56, s56, 17563648
  s_lshl_b32 s58, s71, 8
  s_mul_i32 s69, s40, 108
  s_add_u32 s58, s58, s69
  s_add_u32 s58, s58, 21241856
  s_mul_i32 s57, s71, 81920
  s_mul_i32 s69, s73, 160
  s_add_u32 s57, s57, s69
  s_lshr_b32 s69, s39, 1
  s_lshl1_add_u32 s71, s71, s69
  s_lshl1_add_u32 s71, s71, s40
  s_and_b32 s69, s39, 1
  s_lshl_b32 s69, s69, 8
  s_mul_i32 s54, s71, 55296
  s_add_u32 s54, s54, s69
  s_add_u32 s54, s54, 7864320
  s_mul_i32 s55, s71, 20480
  s_add_u32 s55, s55, s69
  s_add_u32 s55, s55, 14942208
  s_lshr_b32 s60, s71, 2
  s_lshl_b32 s60, s60, 8
  s_add_u32 s60, s60, 21254144
  s_mul_i32 s63, s3, 5120
  v_add_u32 v246, 0, v0
  v_mul_u32_u24 v247, 3277, v246
  v_lshrrev_b32 v247, 16, v247
  v_bfe_u32 v248, v247, 1, 2
  v_xor_b32 v246, v246, v248
  v_mul_u32_u24 v247, 1120, v247
  v_lshl_add_u32 v253, v246, 3, v247
  v_add_u32 v246, 512, v0
  v_mul_u32_u24 v247, 3277, v246
  v_lshrrev_b32 v247, 16, v247
  v_bfe_u32 v248, v247, 1, 2
  v_xor_b32 v246, v246, v248
  v_mul_u32_u24 v247, 1120, v247
  v_lshl_add_u32 v254, v246, 3, v247
  v_lshrrev_b32 v246, 1, v0
  v_add_u32 v246, 1024, v246
  v_mul_u32_u24 v247, 3277, v246
  v_lshrrev_b32 v247, 16, v247
  v_bfe_u32 v248, v247, 1, 2
  v_xor_b32 v246, v246, v248
  v_mul_u32_u24 v247, 1120, v247
  v_lshl_add_u32 v255, v246, 3, v247
  v_and_b32 v246, 1, v0
  v_lshl_add_u32 v255, v246, 2, v255
  v_lshrrev_b32 v246, 4, v1
  v_bfe_u32 v247, v1, 1, 2
  v_xor_b32 v246, v246, v247
  v_and_b32 v247, 15, v1
  v_mul_u32_u24 v14, 320, v247
  v_lshl_add_u32 v14, v246, 4, v14
  s_add_u32 s37, s63, 40960
  v_add_u32 v14, s37, v14
  s_mov_b32 s62, 0
  s_mov_b32 s28, s16
  s_mov_b32 s29, s17
  s_mov_b32 s30, 2211840
  s_add_u32 s37, s81, 16
  s_mul_i32 s82, s37, 40960
  s_add_u32 m0, s84, 40960
  s_nop 0
  buffer_load_dwordx4 v80, s[28:31], s82 offen nt lds
  s_add_u32 m0, s84, 41984
  s_nop 0
  buffer_load_dwordx4 v81, s[28:31], s82 offen nt lds
  s_add_u32 m0, s84, 43008
  s_nop 0
  buffer_load_dwordx4 v82, s[28:31], s82 offen nt lds
  s_add_u32 m0, s84, 44032
  s_nop 0
  buffer_load_dwordx4 v83, s[28:31], s82 offen nt lds
  s_add_u32 m0, s84, 45056
  s_nop 0
  buffer_load_dwordx4 v84, s[28:31], s82 offen nt lds
  s_add_u32 s86, s81, 0
  s_cmp_lt_u32 s86, 54
  s_cselect_b32 s37, 0, 54
  s_cselect_b32 s38, 27, 10
  s_cselect_b32 s85, 0, 27
  s_sub_u32 s86, s86, s37
  s_cmp_ge_u32 s86, s38
  s_cselect_b32 s37, s38, 0
  s_cselect_b32 s38, 1, 0
  s_sub_u32 s86, s86, s37
  s_add_u32 s86, s86, s85
  s_lshl_b32 s37, s3, 1
  s_add_u32 s38, s38, s37
  s_mul_i32 s37, s38, 37
  s_add_u32 s37, s37, s86
  s_mul_i32 s83, s37, 5120
  s_add_u32 s83, s83, 17563648
  s_lshl_b32 s38, s38, 6
  s_add_u32 s86, s86, s38
  s_lshl_b32 s86, s86, 2
  s_add_u32 s87, s86, 21250048
  s_waitcnt vmcnt(5)
  s_barrier
  ds_read_b64_tr_b16 v[92:93], v85
  ds_read_b64_tr_b16 v[94:95], v85 offset:5120
  ds_read_b64_tr_b16 v[96:97], v86
  ds_read_b64_tr_b16 v[98:99], v86 offset:5120
  ds_read_b64_tr_b16 v[100:101], v87
  ds_read_b64_tr_b16 v[102:103], v87 offset:5120
  ds_read_b64_tr_b16 v[104:105], v88
  ds_read_b64_tr_b16 v[106:107], v88 offset:5120
  ds_read_b64_tr_b16 v[108:109], v89
  ds_read_b64_tr_b16 v[110:111], v89 offset:5120
  v_add_u32 v85, 40960, v85
  v_add_u32 v86, 40960, v86
  v_add_u32 v87, 40960, v87
  v_add_u32 v88, 40960, v88
  v_add_u32 v89, 40960, v89
  s_waitcnt lgkmcnt(0)
  buffer_store_dwordx4 v[92:95], v2, s[24:27], s83 offen offset:0 sc1
  buffer_store_dwordx4 v[96:99], v2, s[24:27], s83 offen offset:1024 sc1
  buffer_store_dwordx4 v[100:103], v2, s[24:27], s83 offen offset:2048 sc1
  buffer_store_dwordx4 v[104:107], v2, s[24:27], s83 offen offset:3072 sc1
  s_add_u32 s83, s83, 4096
  buffer_store_dwordx4 v[108:111], v2, s[24:27], s83 offen sc1
  s_mov_b32 s28, s16
  s_mov_b32 s29, s17
  s_mov_b32 s30, 2211840
  s_add_u32 s37, s81, 32
  s_mul_i32 s82, s37, 40960
  s_add_u32 m0, s84, 81920
  s_nop 0
  buffer_load_dwordx4 v80, s[28:31], s82 offen nt lds
  s_add_u32 m0, s84, 82944
  s_nop 0
  buffer_load_dwordx4 v81, s[28:31], s82 offen nt lds
  s_add_u32 m0, s84, 83968
  s_nop 0
  buffer_load_dwordx4 v82, s[28:31], s82 offen nt lds
  s_add_u32 m0, s84, 84992
  s_nop 0
  buffer_load_dwordx4 v83, s[28:31], s82 offen nt lds
  s_add_u32 m0, s84, 86016
  s_nop 0
  buffer_load_dwordx4 v84, s[28:31], s82 offen nt lds
  s_add_u32 s86, s81, 16
  s_cmp_lt_u32 s86, 54
  s_cselect_b32 s37, 0, 54
  s_cselect_b32 s38, 27, 10
  s_cselect_b32 s85, 0, 27
  s_sub_u32 s86, s86, s37
  s_cmp_ge_u32 s86, s38
  s_cselect_b32 s37, s38, 0
  s_cselect_b32 s38, 1, 0
  s_sub_u32 s86, s86, s37
  s_add_u32 s86, s86, s85
  s_lshl_b32 s37, s3, 1
  s_add_u32 s38, s38, s37
  s_mul_i32 s37, s38, 37
  s_add_u32 s37, s37, s86
  s_mul_i32 s83, s37, 5120
  s_add_u32 s83, s83, 17563648
  s_lshl_b32 s38, s38, 6
  s_add_u32 s86, s86, s38
  s_lshl_b32 s86, s86, 2
  s_add_u32 s88, s86, 21250048
  s_waitcnt vmcnt(10)
  s_barrier
  ds_read_b64_tr_b16 v[92:93], v85
  ds_read_b64_tr_b16 v[94:95], v85 offset:5120
  ds_read_b64_tr_b16 v[96:97], v86
  ds_read_b64_tr_b16 v[98:99], v86 offset:5120
  ds_read_b64_tr_b16 v[100:101], v87
  ds_read_b64_tr_b16 v[102:103], v87 offset:5120
  ds_read_b64_tr_b16 v[104:105], v88
  ds_read_b64_tr_b16 v[106:107], v88 offset:5120
  ds_read_b64_tr_b16 v[108:109], v89
  ds_read_b64_tr_b16 v[110:111], v89 offset:5120
  v_add_u32 v85, 40960, v85
  v_add_u32 v86, 40960, v86
  v_add_u32 v87, 40960, v87
  v_add_u32 v88, 40960, v88
  v_add_u32 v89, 40960, v89
  s_waitcnt lgkmcnt(0)
  buffer_store_dwordx4 v[92:95], v2, s[24:27], s83 offen offset:0 sc1
  buffer_store_dwordx4 v[96:99], v2, s[24:27], s83 offen offset:1024 sc1
  buffer_store_dwordx4 v[100:103], v2, s[24:27], s83 offen offset:2048 sc1
  buffer_store_dwordx4 v[104:107], v2, s[24:27], s83 offen offset:3072 sc1
  s_add_u32 s83, s83, 4096
  buffer_store_dwordx4 v[108:111], v2, s[24:27], s83 offen sc1
  s_mov_b32 s37, 819200
  s_add_u32 s38, s81, 48
  s_cmp_lt_u32 s38, 54
  s_cselect_b32 s28, s16, s8
  s_cselect_b32 s29, s17, s9
  s_cselect_b32 s30, 2211840, s37
  s_cselect_b32 s37, 0, 54
  s_sub_u32 s37, s38, s37
  s_mul_i32 s82, s37, 40960
  s_add_u32 m0, s84, 122880
  s_nop 0
  buffer_load_dwordx4 v80, s[28:31], s82 offen nt lds
  s_add_u32 m0, s84, 123904
  s_nop 0
  buffer_load_dwordx4 v81, s[28:31], s82 offen nt lds
  s_add_u32 m0, s84, 124928
  s_nop 0
  buffer_load_dwordx4 v82, s[28:31], s82 offen nt lds
  s_add_u32 m0, s84, 125952
  s_nop 0
  buffer_load_dwordx4 v83, s[28:31], s82 offen nt lds
  s_add_u32 m0, s84, 126976
  s_nop 0
  buffer_load_dwordx4 v84, s[28:31], s82 offen nt lds
  s_add_u32 s86, s81, 32
  s_cmp_lt_u32 s86, 54
  s_cselect_b32 s37, 0, 54
  s_cselect_b32 s38, 27, 10
  s_cselect_b32 s85, 0, 27
  s_sub_u32 s86, s86, s37
  s_cmp_ge_u32 s86, s38
  s_cselect_b32 s37, s38, 0
  s_cselect_b32 s38, 1, 0
  s_sub_u32 s86, s86, s37
  s_add_u32 s86, s86, s85
  s_lshl_b32 s37, s3, 1
  s_add_u32 s38, s38, s37
  s_mul_i32 s37, s38, 37
  s_add_u32 s37, s37, s86
  s_mul_i32 s83, s37, 5120
  s_add_u32 s83, s83, 17563648
  s_lshl_b32 s38, s38, 6
  s_add_u32 s86, s86, s38
  s_lshl_b32 s86, s86, 2
  s_add_u32 s89, s86, 21250048
  s_waitcnt vmcnt(10)
  s_barrier
  ds_read_b64_tr_b16 v[92:93], v85
  ds_read_b64_tr_b16 v[94:95], v85 offset:5120
  ds_read_b64_tr_b16 v[96:97], v86
  ds_read_b64_tr_b16 v[98:99], v86 offset:5120
  ds_read_b64_tr_b16 v[100:101], v87
  ds_read_b64_tr_b16 v[102:103], v87 offset:5120
  ds_read_b64_tr_b16 v[104:105], v88
  ds_read_b64_tr_b16 v[106:107], v88 offset:5120
  ds_read_b64_tr_b16 v[108:109], v89
  ds_read_b64_tr_b16 v[110:111], v89 offset:5120
  v_add_u32 v85, 40960, v85
  v_add_u32 v86, 40960, v86
  v_add_u32 v87, 40960, v87
  v_add_u32 v88, 40960, v88
  v_add_u32 v89, 40960, v89
  s_waitcnt lgkmcnt(0)
  buffer_store_dwordx4 v[92:95], v2, s[24:27], s83 offen offset:0 sc1
  buffer_store_dwordx4 v[96:99], v2, s[24:27], s83 offen offset:1024 sc1
  buffer_store_dwordx4 v[100:103], v2, s[24:27], s83 offen offset:2048 sc1
  buffer_store_dwordx4 v[104:107], v2, s[24:27], s83 offen offset:3072 sc1
  s_add_u32 s83, s83, 4096
  buffer_store_dwordx4 v[108:111], v2, s[24:27], s83 offen sc1
  s_mov_b32 s37, 819200
  s_add_u32 s38, s81, 64
  s_cmp_lt_u32 s38, 54
  s_cselect_b32 s28, s16, s8
  s_cselect_b32 s29, s17, s9
  s_cselect_b32 s30, 2211840, s37
  s_cselect_b32 s37, 0, 54
  s_sub_u32 s37, s38, s37
  s_mul_i32 s82, s37, 40960
  s_add_u32 m0, s84, 0
  s_nop 0
  buffer_load_dwordx4 v80, s[28:31], s82 offen nt lds
  s_add_u32 m0, s84, 1024
  s_nop 0
  buffer_load_dwordx4 v81, s[28:31], s82 offen nt lds
  s_add_u32 m0, s84, 2048
  s_nop 0
  buffer_load_dwordx4 v82, s[28:31], s82 offen nt lds
  s_add_u32 m0, s84, 3072
  s_nop 0
  buffer_load_dwordx4 v83, s[28:31], s82 offen nt lds
  s_add_u32 m0, s84, 4096
  s_nop 0
  buffer_load_dwordx4 v84, s[28:31], s82 offen nt lds
  s_add_u32 s86, s81, 48
  s_cmp_lt_u32 s86, 54
  s_cselect_b32 s37, 0, 54
  s_cselect_b32 s38, 27, 10
  s_cselect_b32 s85, 0, 27
  s_sub_u32 s86, s86, s37
  s_cmp_ge_u32 s86, s38
  s_cselect_b32 s37, s38, 0
  s_cselect_b32 s38, 1, 0
  s_sub_u32 s86, s86, s37
  s_add_u32 s86, s86, s85
  s_lshl_b32 s37, s3, 1
  s_add_u32 s38, s38, s37
  s_mul_i32 s37, s38, 37
  s_add_u32 s37, s37, s86
  s_mul_i32 s83, s37, 5120
  s_add_u32 s83, s83, 17563648
  s_lshl_b32 s38, s38, 6
  s_add_u32 s86, s86, s38
  s_lshl_b32 s86, s86, 2
  s_add_u32 s90, s86, 21250048
  s_waitcnt vmcnt(10)
  s_barrier
  ds_read_b64_tr_b16 v[92:93], v85
  ds_read_b64_tr_b16 v[94:95], v85 offset:5120
  ds_read_b64_tr_b16 v[96:97], v86
  ds_read_b64_tr_b16 v[98:99], v86 offset:5120
  ds_read_b64_tr_b16 v[100:101], v87
  ds_read_b64_tr_b16 v[102:103], v87 offset:5120
  ds_read_b64_tr_b16 v[104:105], v88
  ds_read_b64_tr_b16 v[106:107], v88 offset:5120
  ds_read_b64_tr_b16 v[108:109], v89
  ds_read_b64_tr_b16 v[110:111], v89 offset:5120
  v_add_u32 v85, 4294844416, v85
  v_add_u32 v86, 4294844416, v86
  v_add_u32 v87, 4294844416, v87
  v_add_u32 v88, 4294844416, v88
  v_add_u32 v89, 4294844416, v89
  s_waitcnt lgkmcnt(0)
  buffer_store_dwordx4 v[92:95], v2, s[24:27], s83 offen offset:0 sc1
  buffer_store_dwordx4 v[96:99], v2, s[24:27], s83 offen offset:1024 sc1
  buffer_store_dwordx4 v[100:103], v2, s[24:27], s83 offen offset:2048 sc1
  buffer_store_dwordx4 v[104:107], v2, s[24:27], s83 offen offset:3072 sc1
  s_add_u32 s83, s83, 4096
  buffer_store_dwordx4 v[108:111], v2, s[24:27], s83 offen sc1
  s_add_u32 s86, s81, 64
  s_cmp_lt_u32 s86, 54
  s_cselect_b32 s37, 0, 54
  s_cselect_b32 s38, 27, 10
  s_cselect_b32 s85, 0, 27
  s_sub_u32 s86, s86, s37
  s_cmp_ge_u32 s86, s38
  s_cselect_b32 s37, s38, 0
  s_cselect_b32 s38, 1, 0
  s_sub_u32 s86, s86, s37
  s_add_u32 s86, s86, s85
  s_lshl_b32 s37, s3, 1
  s_add_u32 s38, s38, s37
  s_mul_i32 s37, s38, 37
  s_add_u32 s37, s37, s86
  s_mul_i32 s83, s37, 5120
  s_add_u32 s83, s83, 17563648
  s_lshl_b32 s38, s38, 6
  s_add_u32 s86, s86, s38
  s_lshl_b32 s86, s86, 2
  s_add_u32 s91, s86, 21250048
  s_cmp_lt_u32 s81, 10
  s_cselect_b32 s83, s83, 0x7ff00000
  s_cselect_b32 s91, s91, 0x7ff00000
  s_waitcnt vmcnt(5)
  s_barrier
  ds_read_b64_tr_b16 v[92:93], v85
  ds_read_b64_tr_b16 v[94:95], v85 offset:5120
  ds_read_b64_tr_b16 v[96:97], v86
  ds_read_b64_tr_b16 v[98:99], v86 offset:5120
  ds_read_b64_tr_b16 v[100:101], v87
  ds_read_b64_tr_b16 v[102:103], v87 offset:5120
  ds_read_b64_tr_b16 v[104:105], v88
  ds_read_b64_tr_b16 v[106:107], v88 offset:5120
  ds_read_b64_tr_b16 v[108:109], v89
  ds_read_b64_tr_b16 v[110:111], v89 offset:5120
  s_waitcnt lgkmcnt(0)
  buffer_store_dwordx4 v[92:95], v2, s[24:27], s83 offen offset:0 sc1
  buffer_store_dwordx4 v[96:99], v2, s[24:27], s83 offen offset:1024 sc1
  buffer_store_dwordx4 v[100:103], v2, s[24:27], s83 offen offset:2048 sc1
  buffer_store_dwordx4 v[104:107], v2, s[24:27], s83 offen offset:3072 sc1
  s_add_u32 s83, s83, 4096
  buffer_store_dwordx4 v[108:111], v2, s[24:27], s83 offen sc1
  s_waitcnt vmcnt(0)
  s_mov_b64 exec, 1
  buffer_store_dword v3, off, s[24:27], s87 offset:0 sc1
  s_mov_b64 exec, -1
  s_mov_b64 exec, 1
  buffer_store_dword v3, off, s[24:27], s88 offset:0 sc1
  s_mov_b64 exec, -1
  s_mov_b64 exec, 1
  buffer_store_dword v3, off, s[24:27], s89 offset:0 sc1
  s_mov_b64 exec, -1
  s_mov_b64 exec, 1
  buffer_store_dword v3, off, s[24:27], s90 offset:0 sc1
  s_mov_b64 exec, -1
  s_mov_b64 exec, 1
  buffer_store_dword v3, off, s[24:27], s91 offset:0 sc1
  s_mov_b64 exec, -1
  s_cmp_lg_u32 s3, 4
  s_cbranch_scc1 L_sp_q_done_b
  s_mov_b32 s37, 20979712
  s_mov_b32 s38, 21000192
  s_mov_b32 s94, 21020672
  s_mov_b32 s41, 65536
L_sp_q_b:
  buffer_load_dword v244, v12, s[24:27], s37 offen sc1
  buffer_load_dword v245, v12, s[24:27], s38 offen sc1
  buffer_load_dword v246, v12, s[24:27], s94 offen sc1
  s_waitcnt vmcnt(0)
  v_xor_b32 v244, s36, v244
  v_bitop3_b32 v244, v244, v245, s36 bitop3:0xf6
  v_bitop3_b32 v244, v244, v246, s36 bitop3:0xf6
  v_cmp_ne_u32 vcc, 0, v244
  s_cbranch_vccz L_sp_q_done_b
  s_sleep 8
  s_sub_u32 s41, s41, 1
  s_cmp_lg_u32 s41, 0
  s_cbranch_scc1 L_sp_q_b
L_sp_q_done_b:
  s_barrier
  s_add_u32 m0, s45, 81920
  s_add_u32 s42, s42, 0
  buffer_load_dwordx4 v10, s[24:27], s42 offen sc1 lds
  s_add_u32 m0, s45, 83520
  s_nop 0
  buffer_load_dwordx4 v10, s[24:27], s42 offen offset:512 sc1 lds
  s_add_u32 m0, s45, 86144
  s_add_u32 s43, s43, 0
  buffer_load_dwordx4 v10, s[24:27], s43 offen sc1 lds
  buffer_load_dwordx4 v[228:231], v2, s[24:27], s49 offen sc1
  buffer_load_dwordx4 v[232:235], v2, s[24:27], s48 offen sc1
  buffer_load_dwordx2 v[248:249], v11, s[24:27], s50 offen sc1
  s_branch L_attn
L_sp_h:
  s_mov_b32 s41, 65536
L_sp_h_loop:
  buffer_load_dword v16, v22, s[24:27], s58 offen sc1
  buffer_load_dword v17, v23, s[24:27], s59 offen sc1
  s_waitcnt vmcnt(0)
  v_xor_b32 v16, s36, v16
  v_bitop3_b32 v16, v16, v17, s36 bitop3:0xf6
  v_cmp_ne_u32 vcc, 0, v16
  s_cbranch_vccz L_sp_h_done
  s_sleep 8
  s_sub_u32 s41, s41, 1
  s_cmp_lg_u32 s41, 0
  s_cbranch_scc1 L_sp_h_loop
  s_branch L_sp_h_done
L_slow:
  s_waitcnt lgkmcnt(0)
  s_xor_b32 s93, s3, 4
  s_mul_i32 s93, s93, 3200
  s_add_u32 s93, s93, 133120
  v_cmp_lt_u32 vcc, 31, v1
  v_and_b32 v205, 31, v1
  v_lshlrev_b32 v205, 4, v205
  v_cndmask_b32 v248, 0, v248, vcc
  v_cndmask_b32 v249, 0, v249, vcc
  v_mov_b32 v204, 0xff800000
  v_add_u32 v206, s93, v2
  v_add_u32 v207, s93, v205
  s_bfe_u32 s37, s2, 0x30003
  s_lshl_b32 s37, s37, 2
  s_add_u32 s37, s37, s39
  s_mul_i32 s37, s37, 245760
  s_sub_u32 s91, s50, s37
  s_mul_i32 s38, s40, 122880
  s_add_u32 s37, s37, s38
  s_sub_u32 s90, s48, s37
  s_add_u32 s90, s90, 40960
  s_add_u32 s91, s91, 40960
  v_bfe_u32 v133, v1, 2, 2
  v_lshrrev_b32 v132, 5, v1
  v_lshl_add_u32 v133, v132, 3, v133
  v_lshlrev_b32 v133, 4, v133
  v_and_b32 v134, 1, v1
  v_lshlrev_b32 v134, 9, v134
  v_bfe_u32 v135, v1, 1, 1
  v_lshl_add_u32 v134, v135, 3, v134
  v_mov_b32 v137, 1024
  v_and_b32 v136, 19, v1
  v_cmp_eq_u32 vcc, 16, v136
  v_lshlrev_b32 v135, 3, v135
  v_add_u32 v135, 158848, v135
  v_cndmask_b32 v134, v134, v137, vcc
  v_cmp_lt_u32 vcc, 16, v136
  v_add_u32 v134, s93, v134
  s_nop 0
  v_cndmask_b32 v134, v134, v135, vcc
  v_add_u32 v208, v134, v133
  s_mov_b32 s92, 0
L_slow_a:
  s_add_u32 s37, s90, s92
  s_add_u32 s38, s91, s92
  buffer_load_dwordx4 v[236:239], v2, s[24:27], s37 offen sc1
  buffer_load_dwordx2 v[250:251], v205, s[24:27], s38 offen sc1
  s_waitcnt vmcnt(0)
  v_mfma_f32_32x32x16_bf16 v[164:179], v[236:239], v[232:235], 0
  v_mfma_f32_32x32x8_bf16 v[164:179], v[250:251], v[248:249], v[164:179]
  s_nop 11
  v_max3_f32 v204, v164, v165, v204
  v_max3_f32 v204, v166, v167, v204
  v_max3_f32 v204, v168, v169, v204
  v_max3_f32 v204, v170, v171, v204
  v_max3_f32 v204, v172, v173, v204
  v_max3_f32 v204, v174, v175, v204
  v_max3_f32 v204, v176, v177, v204
  v_max3_f32 v204, v178, v179, v204
  s_add_u32 s92, s92, 122880
  s_cmp_lt_u32 s92, 7864320
  s_cbranch_scc1 L_slow_a
  v_mov_b32 v132, v204
  s_nop 1
  v_permlane32_swap_b32 v132, v204
  v_max_f32 v204, v204, v132
  s_mov_b32 s92, 0
  v_sub_f32 v180, 0, v204
  v_mov_b32 v212, 0
  v_sub_f32 v181, 0, v204
  v_mov_b32 v213, 0
  v_sub_f32 v182, 0, v204
  v_mov_b32 v214, 0
  v_sub_f32 v183, 0, v204
  v_mov_b32 v215, 0
  v_sub_f32 v184, 0, v204
  v_mov_b32 v216, 0
  v_sub_f32 v185, 0, v204
  v_mov_b32 v217, 0
  v_sub_f32 v186, 0, v204
  v_mov_b32 v218, 0
  v_sub_f32 v187, 0, v204
  v_mov_b32 v219, 0
  v_sub_f32 v188, 0, v204
  v_mov_b32 v220, 0
  v_sub_f32 v189, 0, v204
  v_mov_b32 v221, 0
  v_sub_f32 v190, 0, v204
  v_mov_b32 v222, 0
  v_sub_f32 v191, 0, v204
  v_mov_b32 v223, 0
  v_sub_f32 v192, 0, v204
  v_mov_b32 v224, 0
  v_sub_f32 v193, 0, v204
  v_mov_b32 v225, 0
  v_sub_f32 v194, 0, v204
  v_mov_b32 v226, 0
  v_sub_f32 v195, 0, v204
  v_mov_b32 v227, 0
L_slow_b:
  s_add_u32 s37, s90, s92
  s_add_u32 s38, s91, s92
  buffer_load_dwordx4 v[236:239], v2, s[24:27], s37 offen sc1
  buffer_load_dwordx2 v[250:251], v205, s[24:27], s38 offen sc1
  s_add_u32 s37, s37, 40960
  s_add_u32 s38, s38, 40960
  buffer_load_dwordx4 v[196:199], v2, s[24:27], s37 offen sc1
  buffer_load_dwordx2 v[200:201], v205, s[24:27], s38 offen sc1
  s_waitcnt vmcnt(0)
  ds_write_b128 v206, v[196:199]
  ds_write_b64 v207, v[200:201] offset:1024
  v_mfma_f32_32x32x16_bf16 v[164:179], v[236:239], v[232:235], v[180:195]
  v_mfma_f32_32x32x8_bf16 v[164:179], v[250:251], v[248:249], v[164:179]
  s_waitcnt lgkmcnt(0)
  ds_read_b64_tr_b16 v[240:241], v208 offset:0
  ds_read_b64_tr_b16 v[242:243], v208 offset:64
  ds_read_b64_tr_b16 v[244:245], v208 offset:256
  ds_read_b64_tr_b16 v[246:247], v208 offset:320
  s_nop 6
  v_exp_f32 v164, v164
  v_exp_f32 v165, v165
  v_exp_f32 v166, v166
  v_exp_f32 v167, v167
  v_exp_f32 v168, v168
  v_exp_f32 v169, v169
  v_exp_f32 v170, v170
  v_exp_f32 v171, v171
  v_exp_f32 v172, v172
  v_exp_f32 v173, v173
  v_exp_f32 v174, v174
  v_exp_f32 v175, v175
  v_exp_f32 v176, v176
  v_exp_f32 v177, v177
  v_exp_f32 v178, v178
  v_exp_f32 v179, v179
  s_waitcnt lgkmcnt(0)
  v_smfmac_f32_32x32x32_bf16 v[212:227], v[240:243], v[164:171], v4
  v_smfmac_f32_32x32x32_bf16 v[212:227], v[244:247], v[172:179], v4
  s_add_u32 s92, s92, 122880
  s_cmp_lt_u32 s92, 7864320
  s_cbranch_scc1 L_slow_b
  s_nop 8
  v_mov_b32 v132, v212
  v_mov_b32 v133, v213
  v_mov_b32 v134, v214
  v_mov_b32 v135, v215
  v_mov_b32 v136, v216
  v_mov_b32 v137, v217
  v_mov_b32 v138, v218
  v_mov_b32 v139, v219
  v_mov_b32 v140, v220
  v_mov_b32 v141, v221
  v_mov_b32 v142, v222
  v_mov_b32 v143, v223
  v_mov_b32 v144, v220
  v_mov_b32 v145, v220
  s_nop 1
  v_permlane32_swap_b32 v145, v144
  ds_read_b128 v[164:167], v11 offset:0
  ds_read_b128 v[168:171], v11 offset:1024
  ds_read_b128 v[172:175], v11 offset:2048
  ds_read_b128 v[176:179], v11 offset:3072
  ds_read_b128 v[180:183], v11 offset:4096
  ds_read_b128 v[184:187], v11 offset:5120
  ds_read_b128 v[188:191], v11 offset:6144
  ds_read_b128 v[192:195], v11 offset:7168
  ds_read_b128 v[196:199], v11 offset:8192
  ds_read_b128 v[200:203], v11 offset:9216
  s_branch L_slow_done
.section .rodata,"a"
.p2align 6
.amdhsa_kernel recurrent_scan__softmax_full_mha__geglu_ffn__prompt_kernel
  .amdhsa_next_free_vgpr 256
  .amdhsa_next_free_sgpr 102
  .amdhsa_accum_offset 256
  .amdhsa_group_segment_fixed_size 0
  .amdhsa_kernarg_size 80
  .amdhsa_user_sgpr_count 2
  .amdhsa_user_sgpr_kernarg_segment_ptr 1
  .amdhsa_system_sgpr_workgroup_id_x 1
.end_amdhsa_kernel
```
